```python
import torch

def _softmax(x, axis=-1):
    return torch.softmax(x, dim=axis)
def _gelu(x):
    return torch.nn.functional.gelu(x, approximate="tanh")
def _silu(x):
    return torch.nn.functional.silu(x)
def _sigmoid(x):
    return torch.sigmoid(x)
def _layernorm(x, axis=-1, eps=1e-5):
    m = x.mean(dim=axis, keepdim=True)
    v = x.var(dim=axis, keepdim=True, unbiased=False)
    return (x - m) / torch.sqrt(v + eps)
def _scatter_add(tgt, idx, src, axis=0):
    return tgt.clone().index_add_(axis, idx, src)
def _segment_sum(src, seg, n):
    out = torch.zeros((n,) + src.shape[1:], dtype=src.dtype)
    return out.index_add_(0, seg, src)
def _pad(x, pw):
    flat = tuple(v for pair in reversed(pw) for v in pair)
    return torch.nn.functional.pad(x, flat)

kernel_name = 'parallel_sum__compressed_kv_cla__glu_gated_bilinear__decode'

def setup_inputs():

    _w = (lambda a: (lambda t: t.to(torch.bfloat16) if t.is_floating_point() else t)(torch.as_tensor(a)))
    def _A_setup():
        B, H, Sq, Sk, D, M = 1, 32, 1, 16384, 128, 512
        Dc = 4 * D
        return {
            "x": _w((lambda *s: torch.randn(*s, dtype=torch.bfloat16) * 0.05)(B, Sq, M)),
            "c_kv": _w((lambda *s: torch.randn(*s, dtype=torch.bfloat16) * 0.8)(B, Sk, Dc)),
            "w_q": _w((lambda *s: torch.randn(*s, dtype=torch.bfloat16) * 1.6)(M, H, D) * (M ** -0.5)),
            "w_uk": _w((lambda *s: torch.randn(*s, dtype=torch.bfloat16) * 1.6)(Dc, H, D) * (Dc ** -0.5)),
            "w_uv": _w((lambda *s: torch.randn(*s, dtype=torch.bfloat16) * 0.8)(Dc, H, D) * (Dc ** -0.5)),
            "w_o": _w((lambda *s: torch.randn(*s, dtype=torch.bfloat16) * 0.8)(H, D, M) * ((H * D) ** -0.5)),
        }
    _A_in = _A_setup()

    def _B_setup():
        B, S, D, F = 1, 1, 512, 1376
        return {
            "x": _w((lambda *s: torch.randn(*s, dtype=torch.bfloat16) * 0.05)(B, S, D)),
            "w_gate": _w((lambda *s: torch.randn(*s, dtype=torch.bfloat16) * 0.4)(D, F) * (D ** -0.5)),
            "w_up": _w((lambda *s: torch.randn(*s, dtype=torch.bfloat16) * 0.4)(D, F) * (D ** -0.5)),
            "w_down": _w((lambda *s: torch.randn(*s, dtype=torch.bfloat16) * 0.4)(F, D) * (F ** -0.5)),
        }
    _B_in = _B_setup()

    return {
        "A_x": _A_in["x"],
        "A_c_kv": _A_in["c_kv"],
        "A_w_q": _A_in["w_q"],
        "A_w_uk": _A_in["w_uk"],
        "A_w_uv": _A_in["w_uv"],
        "A_w_o": _A_in["w_o"],
        "B_x": _B_in["x"],
        "B_w_gate": _B_in["w_gate"],
        "B_w_up": _B_in["w_up"],
        "B_w_down": _B_in["w_down"],
    }

def reference(A_x, A_c_kv, A_w_q, A_w_uk, A_w_uv, A_w_o, B_x, B_w_gate, B_w_up, B_w_down):
    def _A_ref(x, c_kv, w_q, w_uk, w_uv, w_o):
        B, Sq, M = x.shape[0], x.shape[1], x.shape[2]
        Sk = c_kv.shape[1]
        H, D = w_q.shape[1], w_q.shape[2]
        q = torch.einsum("bqm,mhd->bhqd", x, w_q)
        k = torch.einsum("bkc,chd->bhkd", c_kv, w_uk)
        v = torch.einsum("bkc,chd->bhkd", c_kv, w_uv)
        scores = torch.einsum("bhqd,bhkd->bhqk", q, k) * (D ** -0.5)
        off = Sk - Sq
        qi = torch.arange(Sq)[:, None]
        kj = torch.arange(Sk)[None, :]
        cmask = kj <= (qi + off)
        scores = torch.where(cmask[None, None], scores, -1e9)
        p = _softmax(scores, axis=-1)
        ctx = torch.einsum("bhqk,bhkd->bhqd", p, v)
        return torch.einsum("bhqd,hdm->bqm", ctx, w_o)

    def _B_ref(x, w_gate, w_up, w_down):
        g = torch.einsum("bsd,df->bsf", x, w_gate)
        u = torch.einsum("bsd,df->bsf", x, w_up)
        h = g * u
        return torch.einsum("bsf,fd->bsd", h, w_down)

    x = A_x
    xn = _layernorm(x, axis=-1)
    return x + _A_ref(xn, A_c_kv, A_w_q, A_w_uk, A_w_uv, A_w_o) + _B_ref(xn, B_w_gate, B_w_up, B_w_down)
```

```asm
; @launch grid=(256,1,1) block=(512,1,1) lds=163840
.amdgcn_target "amdgcn-amd-amdhsa--gfx950"
.text
.globl parallel_sum__compressed_kv_cla__glu_gated_bilinear__decode_kernel
.p2align 8
.type parallel_sum__compressed_kv_cla__glu_gated_bilinear__decode_kernel,@function
parallel_sum__compressed_kv_cla__glu_gated_bilinear__decode_kernel:

    s_load_dwordx16 s[4:19], s[0:1], 0
    s_load_dwordx8 s[20:27], s[0:1], 64
    s_load_dwordx2 s[28:29], s[0:1], 96
    s_cmp_ge_u32 s2, 256
    s_cbranch_scc1 L_end
    s_bitcmp1_b32 s2, 3
    s_cbranch_scc0 L_nopf
    s_getpc_b64 s[30:31]
L_pc:
    v_lshlrev_b32 v1, 5, v0
    v_min_u32 v1, L_end-L_pc, v1
    global_load_dword v255, v1, s[30:31]
L_nopf:
    v_lshrrev_b32 v4, 6, v0
    v_and_b32 v1, 63, v0
    v_readfirstlane_b32 s72, v4
    v_and_b32 v2, 15, v0
    v_lshrrev_b32 v6, 4, v0
    s_and_b32 s73, s2, 7
    s_lshr_b32 s74, s2, 4
    v_lshlrev_b32 v6, 15, v6
    s_and_b32 s76, s74, 3
    s_and_b32 s75, s74, 12
    v_lshl_add_u32 v6, v2, 4, v6

    s_lshl1_add_u32 s75, s75, s73

    s_lshl_b32 s81, s76, 12
    s_add_u32 s81, s81, s75
    s_lshl_b32 s81, s81, 8
    v_lshlrev_b32 v5, 4, v1
    v_add_u32 v6, s81, v6
    v_bfe_u32 v3, v0, 4, 2
    s_movk_i32 s78, 0x2000
    s_movk_i32 s79, 0x4000
    s_movk_i32 s80, 0x6000
    s_mov_b32 s42, 0x400000
    s_mov_b32 s43, 0x20000
    s_mov_b32 s46, 0x400000
    s_mov_b32 s47, 0x20000
    s_lshl4_add_u32 s77, s73, s74
    v_add_u32 v7, s76, v3
    v_and_b32 v7, 3, v7
    v_lshlrev_b32 v7, 3, v7
    v_add_u32 v7, s72, v7
    v_lshl_add_u32 v7, v7, 4, v2
    v_lshlrev_b32 v7, 1, v7
    s_bitcmp1_b32 s2, 3
    s_waitcnt lgkmcnt(0)
    s_mov_b64 s[40:41], s[8:9]
    s_mov_b64 s[44:45], s[10:11]

    s_cbranch_scc1 L_A
    global_load_dwordx4 v[8:11], v5, s[4:5]
    global_load_ushort v213, v7, s[4:5]
    s_barrier
    buffer_load_dwordx4 v[16:19], v6, s[40:43], 0 offen
    buffer_load_dwordx4 v[20:23], v6, s[40:43], s78 offen
    buffer_load_dwordx4 v[24:27], v6, s[40:43], s79 offen
    buffer_load_dwordx4 v[28:31], v6, s[40:43], s80 offen
    v_add_u32 v201, 1048576, v6
    v_and_b32 v201, 0x3fffff, v201
    v_add_u32 v202, 2097152, v6
    v_and_b32 v202, 0x3fffff, v202
    v_add_u32 v203, 3145728, v6
    v_and_b32 v203, 0x3fffff, v203
    v_and_b32 v13, 1, v2
    v_lshlrev_b32 v13, 4, v13
    s_mov_b32 s84, 0x00030003
    s_mov_b32 s85, 0x00030003
    s_mov_b32 s86, 0xffff
    v_lshlrev_b32 v13, v13, s86
    v_cndmask_b32 v232, 0, v13, s[84:85]
    s_lshl_b64 s[84:85], s[84:85], 2
    v_cndmask_b32 v233, 0, v13, s[84:85]
    s_lshl_b64 s[84:85], s[84:85], 2
    v_cndmask_b32 v234, 0, v13, s[84:85]
    s_lshl_b64 s[84:85], s[84:85], 2
    v_cndmask_b32 v235, 0, v13, s[84:85]
    v_lshlrev_b32 v205, 2, v0
    v_add_u32 v205, 149504, v205
    s_lshl_b32 s84, s72, 8
    s_add_u32 s84, s84, 149504
    v_lshl_add_u32 v206, v3, 4, s84
    v_add_u32 v210, 147456, v7
    v_mov_b32 v12, 0
    v_mov_b32 v14, 0
    v_mov_b32 v96, 0x3f803f80
    v_lshrrev_b32 v212, 4, v0
    v_lshlrev_b32 v212, 3, v212
    v_and_b32 v13, 4, v2
    v_or_b32 v212, v212, v13
    v_bfe_u32 v13, v2, 3, 1
    v_lshl_or_b32 v212, v13, 1, v212
    v_add_u32 v212, 148480, v212
    v_lshlrev_b32 v214, 2, v1
    v_add_u32 v215, 148480, v214
    s_lshl2_add_u32 s89, s75, s76
    s_lshl_b32 s89, s89, 8
    v_lshlrev_b32 v204, 4, v0
    v_add_u32 v204, 155648, v204
    v_lshrrev_b32 v211, 1, v3
    v_lshlrev_b32 v211, 8, v211
    v_lshl_or_b32 v211, v2, 4, v211
    v_and_b32 v13, 1, v3
    v_lshl_or_b32 v211, v13, 3, v211
    v_add_u32 v211, 155648, v211
    v_mov_b32 v236, 0
    v_mov_b32 v237, 0
    v_mov_b32 v238, 0
    v_mov_b32 v239, 0
    s_mov_b64 s[36:37], s[28:29]
    s_mov_b32 s38, 5242880
    s_mov_b32 s39, 0x20000
    s_mov_b64 s[32:33], s[6:7]
    s_mov_b32 s34, 0x1000000
    s_mov_b32 s35, 0x20000
    s_and_b32 s84, s72, 1
    s_bfe_u32 s85, s72, 0x10001
    s_lshl3_add_u32 s84, s84, s85
    s_lshl_b32 s84, s84, 4
    v_xor_b32 v224, s84, v5
    s_lshl_b32 s82, s72, 14
    s_lshl_b32 s92, s72, 12
    s_lshl_b32 s83, s77, 15
    s_add_u32 s83, s83, s92
    v_xor_b32 v225, 32, v224
    v_xor_b32 v226, 64, v224
    v_xor_b32 v227, 96, v224
    s_waitcnt vmcnt(4)
    v_dot2c_f32_bf16 v12, v8, v96
    v_dot2c_f32_bf16 v14, v8, v8
    v_dot2c_f32_bf16 v12, v9, v96
    v_dot2c_f32_bf16 v14, v9, v9
    v_dot2c_f32_bf16 v12, v10, v96
    v_dot2c_f32_bf16 v14, v10, v10
    v_dot2c_f32_bf16 v12, v11, v96
    v_dot2c_f32_bf16 v14, v11, v11
    v_lshlrev_b32 v213, 16, v213
    s_nop 0
    v_add_f32_dpp v12, v12, v12 row_ror:8 row_mask:0xf bank_mask:0xf
    v_add_f32_dpp v14, v14, v14 row_ror:8 row_mask:0xf bank_mask:0xf
    s_nop 0
    v_add_f32_dpp v12, v12, v12 row_ror:4 row_mask:0xf bank_mask:0xf
    v_add_f32_dpp v14, v14, v14 row_ror:4 row_mask:0xf bank_mask:0xf
    s_nop 0
    v_add_f32_dpp v12, v12, v12 row_ror:2 row_mask:0xf bank_mask:0xf
    v_add_f32_dpp v14, v14, v14 row_ror:2 row_mask:0xf bank_mask:0xf
    s_nop 0
    v_add_f32_dpp v12, v12, v12 row_ror:1 row_mask:0xf bank_mask:0xf
    v_add_f32_dpp v14, v14, v14 row_ror:1 row_mask:0xf bank_mask:0xf
    v_mov_b32 v13, v12
    v_mov_b32 v15, v14
    s_nop 0
    v_permlane16_swap_b32 v12, v13
    v_permlane16_swap_b32 v14, v15
    v_add_f32 v12, v12, v13
    v_add_f32 v14, v14, v15
    v_mov_b32 v13, v12
    v_mov_b32 v15, v14
    s_nop 0
    v_permlane32_swap_b32 v12, v13
    v_permlane32_swap_b32 v14, v15
    v_add_f32 v12, v12, v13
    v_add_f32 v14, v14, v15
    v_mul_f32 v12, 0x3b000000, v12
    v_mul_f32 v14, 0x3b000000, v14
    v_fma_f32 v14, -v12, v12, v14
    v_max_f32 v14, 0, v14
    v_cvt_pk_bf16_f32 v12, v12, v14
    v_and_b32 v14, 0xffff0000, v12
    v_lshlrev_b32 v12, 16, v12
    v_add_f32 v14, 0x3727c5ac, v14
    v_sub_f32 v213, v213, v12
    v_cvt_pk_bf16_f32 v14, v213, v14
    v_lshlrev_b32 v213, 16, v14
    v_and_b32 v14, 0xffff0000, v14
    v_sqrt_f32 v14, v14
    s_nop 0
    v_cvt_pk_bf16_f32 v14, v14, v14
    v_and_b32 v14, 0xffff0000, v14
    v_rcp_f32 v14, v14
    s_nop 0
    v_mul_f32 v213, v213, v14
    v_cvt_pk_bf16_f32 v213, v213, v213
    ds_write_b32 v205, v213
    ds_write_b16 v210, v213
    ds_read_b128 v[160:163], v206 offset:0
    ds_read_b128 v[164:167], v206 offset:64
    ds_read_b128 v[168:171], v206 offset:128
    ds_read_b128 v[172:175], v206 offset:192
    buffer_load_dwordx4 v[32:35], v201, s[40:43], 0 offen
    buffer_load_dwordx4 v[36:39], v201, s[40:43], s78 offen
    buffer_load_dwordx4 v[40:43], v201, s[40:43], s79 offen
    buffer_load_dwordx4 v[44:47], v201, s[40:43], s80 offen
    s_waitcnt lgkmcnt(0)
    v_and_b32 v96, v160, v232
    v_and_b32 v97, v160, v233
    v_and_b32 v98, v160, v234
    v_and_b32 v99, v160, v235
    v_and_b32 v100, v161, v232
    v_and_b32 v101, v161, v233
    v_and_b32 v102, v161, v234
    v_and_b32 v103, v161, v235
    v_and_b32 v104, v162, v232
    v_and_b32 v105, v162, v233
    v_and_b32 v106, v162, v234
    v_and_b32 v107, v162, v235
    v_and_b32 v108, v163, v232
    v_and_b32 v109, v163, v233
    v_and_b32 v110, v163, v234
    v_and_b32 v111, v163, v235
    v_and_b32 v112, v164, v232
    v_and_b32 v113, v164, v233
    v_and_b32 v114, v164, v234
    v_and_b32 v115, v164, v235
    v_and_b32 v116, v165, v232
    v_and_b32 v117, v165, v233
    v_and_b32 v118, v165, v234
    v_and_b32 v119, v165, v235
    v_and_b32 v120, v166, v232
    v_and_b32 v121, v166, v233
    v_and_b32 v122, v166, v234
    v_and_b32 v123, v166, v235
    v_and_b32 v124, v167, v232
    v_and_b32 v125, v167, v233
    v_and_b32 v126, v167, v234
    v_and_b32 v127, v167, v235
    buffer_load_dwordx4 v[48:51], v202, s[40:43], 0 offen
    buffer_load_dwordx4 v[52:55], v202, s[40:43], s78 offen
    buffer_load_dwordx4 v[56:59], v202, s[40:43], s79 offen
    buffer_load_dwordx4 v[60:63], v202, s[40:43], s80 offen
    s_waitcnt vmcnt(8)
    v_mfma_f32_16x16x32_bf16 v[176:179], v[96:99], v[16:19], 0
    v_mfma_f32_16x16x32_bf16 v[176:179], v[100:103], v[20:23], v[176:179]
    v_mfma_f32_16x16x32_bf16 v[176:179], v[104:107], v[24:27], v[176:179]
    v_mfma_f32_16x16x32_bf16 v[176:179], v[108:111], v[28:31], v[176:179]
    v_and_b32 v128, v168, v232
    v_and_b32 v129, v168, v233
    v_and_b32 v130, v168, v234
    v_and_b32 v131, v168, v235
    v_and_b32 v132, v169, v232
    v_and_b32 v133, v169, v233
    v_and_b32 v134, v169, v234
    v_and_b32 v135, v169, v235
    v_and_b32 v136, v170, v232
    v_and_b32 v137, v170, v233
    v_and_b32 v138, v170, v234
    v_and_b32 v139, v170, v235
    v_and_b32 v140, v171, v232
    v_and_b32 v141, v171, v233
    v_and_b32 v142, v171, v234
    v_and_b32 v143, v171, v235
    v_and_b32 v144, v172, v232
    v_and_b32 v145, v172, v233
    v_and_b32 v146, v172, v234
    v_and_b32 v147, v172, v235
    v_and_b32 v148, v173, v232
    v_and_b32 v149, v173, v233
    v_and_b32 v150, v173, v234
    v_and_b32 v151, v173, v235
    v_and_b32 v152, v174, v232
    v_and_b32 v153, v174, v233
    v_and_b32 v154, v174, v234
    v_and_b32 v155, v174, v235
    v_and_b32 v156, v175, v232
    v_and_b32 v157, v175, v233
    v_and_b32 v158, v175, v234
    v_and_b32 v159, v175, v235
    buffer_load_dwordx4 v[64:67], v203, s[40:43], 0 offen
    buffer_load_dwordx4 v[68:71], v203, s[40:43], s78 offen
    buffer_load_dwordx4 v[72:75], v203, s[40:43], s79 offen
    buffer_load_dwordx4 v[76:79], v203, s[40:43], s80 offen
    s_waitcnt vmcnt(8)
    v_mfma_f32_16x16x32_bf16 v[176:179], v[112:115], v[32:35], v[176:179]
    v_mfma_f32_16x16x32_bf16 v[176:179], v[116:119], v[36:39], v[176:179]
    v_mfma_f32_16x16x32_bf16 v[176:179], v[120:123], v[40:43], v[176:179]
    v_mfma_f32_16x16x32_bf16 v[176:179], v[124:127], v[44:47], v[176:179]
    s_barrier
    buffer_load_dwordx4 v[80:83], v6, s[44:47], 0 offen
    s_waitcnt vmcnt(5)
    v_mfma_f32_16x16x32_bf16 v[176:179], v[128:131], v[48:51], v[176:179]
    v_mfma_f32_16x16x32_bf16 v[176:179], v[132:135], v[52:55], v[176:179]
    v_mfma_f32_16x16x32_bf16 v[176:179], v[136:139], v[56:59], v[176:179]
    v_mfma_f32_16x16x32_bf16 v[176:179], v[140:143], v[60:63], v[176:179]
    buffer_load_dwordx4 v[84:87], v6, s[44:47], s78 offen
    s_waitcnt vmcnt(2)
    v_mfma_f32_16x16x32_bf16 v[176:179], v[144:147], v[64:67], v[176:179]
    v_mfma_f32_16x16x32_bf16 v[176:179], v[148:151], v[68:71], v[176:179]
    v_mfma_f32_16x16x32_bf16 v[176:179], v[152:155], v[72:75], v[176:179]
    v_mfma_f32_16x16x32_bf16 v[176:179], v[156:159], v[76:79], v[176:179]
    s_nop 7
    ds_write_b128 v204, v[176:179]
    buffer_load_dwordx4 v[88:91], v6, s[44:47], s79 offen
    s_waitcnt lgkmcnt(0)
    s_barrier
    ds_read2st64_b64 v[152:155], v211 offset0:0 offset1:2
    ds_read2st64_b64 v[156:159], v211 offset0:4 offset1:6
    ds_read2st64_b64 v[160:163], v211 offset0:8 offset1:10
    ds_read2st64_b64 v[164:167], v211 offset0:12 offset1:14
    buffer_load_dwordx4 v[92:95], v6, s[44:47], s80 offen
    s_waitcnt lgkmcnt(3)
    v_add_f32 v152, v152, v154
    v_add_f32 v153, v153, v155
    s_waitcnt lgkmcnt(2)
    v_add_f32 v156, v156, v158
    v_add_f32 v157, v157, v159
    v_add_f32 v152, v152, v156
    v_add_f32 v153, v153, v157
    s_waitcnt lgkmcnt(1)
    v_add_f32 v160, v160, v162
    v_add_f32 v161, v161, v163
    s_waitcnt lgkmcnt(0)
    v_add_f32 v164, v164, v166
    v_add_f32 v165, v165, v167
    v_add_f32 v160, v160, v164
    v_add_f32 v161, v161, v165
    v_add_f32 v152, v152, v160
    v_add_f32 v153, v153, v161
    v_cvt_pk_bf16_f32 v160, v152, v153
    v_mov_b32 v161, v160
    s_load_dwordx8 s[64:71], s[26:27], 0
    s_nop 0
    v_permlane16_swap_b32 v160, v161
    v_mov_b32 v162, v160
    v_mov_b32 v163, v161
    s_nop 0
    v_permlane32_swap_b32 v160, v162
    v_permlane32_swap_b32 v161, v163
    s_waitcnt vmcnt(1)
    v_dot2c_f32_bf16 v236, v80, v160
    v_dot2c_f32_bf16 v236, v81, v161
    v_dot2c_f32_bf16 v236, v82, v162
    v_dot2c_f32_bf16 v236, v83, v163
    v_dot2c_f32_bf16 v237, v84, v160
    v_dot2c_f32_bf16 v237, v85, v161
    v_dot2c_f32_bf16 v237, v86, v162
    v_dot2c_f32_bf16 v237, v87, v163
    v_dot2c_f32_bf16 v238, v88, v160
    v_dot2c_f32_bf16 v238, v89, v161
    v_dot2c_f32_bf16 v238, v90, v162
    v_dot2c_f32_bf16 v238, v91, v163
    s_waitcnt vmcnt(0)
    v_dot2c_f32_bf16 v239, v92, v160
    v_dot2c_f32_bf16 v239, v93, v161
    v_dot2c_f32_bf16 v239, v94, v162
    v_dot2c_f32_bf16 v239, v95, v163
    v_add_f32_dpp v12, v236, v236 row_ror:8 row_mask:0xf bank_mask:0x3
    v_add_f32_dpp v13, v238, v238 row_ror:8 row_mask:0xf bank_mask:0x3
    s_cmp_lg_u32 s72, 0
    v_add_f32_dpp v12, v237, v237 row_ror:8 row_mask:0xf bank_mask:0xc
    v_add_f32_dpp v13, v239, v239 row_ror:8 row_mask:0xf bank_mask:0xc
    s_nop 0
    v_add_f32_dpp v14, v12, v12 row_half_mirror row_mask:0xf bank_mask:0x5
    s_nop 1
    v_add_f32_dpp v14, v13, v13 row_half_mirror row_mask:0xf bank_mask:0xa
    s_nop 1
    v_add_f32_dpp v14, v14, v14 quad_perm:[1,0,3,2] row_mask:0xf bank_mask:0xf
    s_nop 1
    v_add_f32_dpp v14, v14, v14 quad_perm:[2,3,0,1] row_mask:0xf bank_mask:0xf
    v_mul_f32 v14, 0x3e0293ee, v14
    v_cvt_pk_bf16_f32 v14, v14, v14
    ds_write_b16 v212, v14
    s_waitcnt lgkmcnt(0)
    s_barrier
    s_cbranch_scc1 L_nopub_1
    ds_read_b32 v12, v215
    s_and_b64 s[64:65], s[64:65], s[66:67]
    s_and_b64 s[68:69], s[68:69], s[70:71]
    s_and_b64 s[64:65], s[64:65], s[68:69]
    s_mov_b32 s87, 0
    s_and_b32 s64, s64, s65
    s_cbranch_scc1 L_rdyok_3
    v_and_b32 v14, 7, v1
    v_lshlrev_b32 v14, 2, v14
L_rdy_2:
    global_load_dword v13, v14, s[26:27] sc1
    s_add_u32 s87, s87, 1
    s_waitcnt vmcnt(0)
    v_cmp_eq_u32 vcc, 0, v13
    s_cmp_lt_u32 s87, 32768
    s_cbranch_vccz L_rdyok_3
    s_cbranch_scc1 L_rdy_2
L_rdyok_3:
    s_waitcnt lgkmcnt(0)
    buffer_store_dword v12, v214, s[36:39], s89 offen sc1
L_nopub_1:
    s_add_u32 m0, s92, 0
    s_nop 0
    buffer_load_dwordx4 v224, s[32:35], s83 offen offset:0  lds
    buffer_load_dwordx4 v225, s[32:35], s83 offen offset:1024  lds
    buffer_load_dwordx4 v226, s[32:35], s83 offen offset:2048  lds
    buffer_load_dwordx4 v227, s[32:35], s83 offen offset:3072  lds
    v_and_b32 v180, 7, v2
    v_lshrrev_b32 v181, 3, v2
    v_lshl_or_b32 v180, v180, 1, v181
    v_lshlrev_b32 v181, 1, v3
    v_xor_b32 v180, v180, v181
    v_lshlrev_b32 v180, 4, v180
    v_lshl_or_b32 v180, v2, 10, v180
    s_lshl_b32 s84, s72, 14
    v_add_u32 v184, 131072, v180
    v_add_u32 v180, s84, v180
    v_xor_b32 v181, 16, v180
    v_xor_b32 v185, 16, v184
    v_xor_b32 v182, 128, v180
    v_xor_b32 v186, 128, v184
    v_xor_b32 v183, 144, v180
    v_xor_b32 v187, 144, v184
    s_barrier
    s_add_u32 m0, s92, 32768
    s_add_u32 s83, s83, 4194304
    buffer_load_dwordx4 v224, s[32:35], s83 offen offset:0  lds
    buffer_load_dwordx4 v225, s[32:35], s83 offen offset:1024  lds
    buffer_load_dwordx4 v226, s[32:35], s83 offen offset:2048  lds
    buffer_load_dwordx4 v227, s[32:35], s83 offen offset:3072  lds
    s_and_b32 s84, s72, 3
    s_lshr_b32 s85, s72, 2
    s_lshl2_add_u32 s84, s84, s85
    s_lshl_b32 s84, s84, 4
    v_xor_b32 v196, s84, v5
    s_lshl_b32 s30, s72, 11
    s_add_u32 s84, s30, 0
    v_add_u32 v196, s84, v196
    v_xor_b32 v197, 32, v196
    s_add_u32 s30, s30, 131072
    s_mov_b32 s31, 0
    v_lshlrev_b32 v249, 5, v2
    v_add_u32 v249, 148992, v249
    s_lshl_b32 s84, s72, 2
    v_add_u32 v248, s84, v249
    v_lshrrev_b32 v252, 5, v0
    v_and_b32 v4, 31, v0
    v_lshlrev_b32 v252, 15, v252
    v_lshl_or_b32 v252, v4, 2, v252
    v_mov_b32 v247, -1
    s_mov_b32 s56, 0x20000
    s_mov_b32 s57, 0x40000
    s_mov_b32 s58, 0x60000
    s_lshl_b32 s59, s77, 3
    s_add_u32 s59, s59, 32768
    s_barrier
    s_add_u32 m0, s92, 65536
    s_add_u32 s83, s83, 4194304
    buffer_load_dwordx4 v224, s[32:35], s83 offen offset:0  lds
    buffer_load_dwordx4 v225, s[32:35], s83 offen offset:1024  lds
    buffer_load_dwordx4 v226, s[32:35], s83 offen offset:2048  lds
    buffer_load_dwordx4 v227, s[32:35], s83 offen offset:3072  lds
    s_barrier
    s_add_u32 m0, s92, 98304
    s_add_u32 s83, s83, 4194304
    buffer_load_dwordx4 v224, s[32:35], s83 offen offset:0  lds
    buffer_load_dwordx4 v225, s[32:35], s83 offen offset:1024  lds
    buffer_load_dwordx4 v226, s[32:35], s83 offen offset:2048  lds
    buffer_load_dwordx4 v227, s[32:35], s83 offen offset:3072  lds
    s_waitcnt vmcnt(8)
    s_barrier
    s_cmp_lt_u32 s72, 4
    s_cbranch_scc0 L_ar_4
    ds_read_b128 v[80:83], v180 offset:0
    ds_read_b128 v[84:87], v181 offset:0
    ds_read_b128 v[88:91], v182 offset:0
    ds_read_b128 v[92:95], v183 offset:0
    ds_read_b128 v[96:99], v180 offset:256
    ds_read_b128 v[100:103], v181 offset:256
    ds_read_b128 v[104:107], v182 offset:256
    ds_read_b128 v[108:111], v183 offset:256
    ds_read_b128 v[112:115], v180 offset:512
    ds_read_b128 v[116:119], v181 offset:512
    ds_read_b128 v[120:123], v182 offset:512
    ds_read_b128 v[124:127], v183 offset:512
    ds_read_b128 v[128:131], v180 offset:768
    ds_read_b128 v[132:135], v181 offset:768
    ds_read_b128 v[136:139], v182 offset:768
    ds_read_b128 v[140:143], v183 offset:768
L_ar_4:
    v_lshrrev_b32 v192, 2, v1
    v_and_b32 v188, 7, v192
    v_lshrrev_b32 v189, 3, v192
    v_lshl_or_b32 v188, v188, 1, v189
    v_bfe_u32 v189, v1, 1, 1
    s_lshl_b32 s84, s72, 1
    v_or_b32 v189, s84, v189
    v_xor_b32 v188, v188, v189
    v_lshlrev_b32 v188, 4, v188
    v_lshl_or_b32 v188, v192, 10, v188
    v_and_b32 v189, 1, v1
    v_lshl_or_b32 v188, v189, 3, v188
    v_add_u32 v189, 0x10000, v188
    s_lshr_b32 s84, s72, 1
    s_and_b32 s85, s72, 1
    s_lshl_b32 s86, s84, 10
    s_lshl3_add_u32 s86, s85, s86
    s_add_u32 s86, s86, 151552
    v_add_u32 v250, s86, v5
    v_add_u32 v253, 151552, v5
    v_lshlrev_b32 v251, 19, v3
    v_lshl_or_b32 v251, v2, 3, v251
    s_lshl_b32 s84, s84, 15
    s_lshl_b32 s85, s85, 7
    s_add_u32 s84, s84, s85
    s_lshl_b32 s85, s77, 8
    s_add_u32 s84, s84, s85
    s_add_u32 s84, s84, 1048576
    v_add_u32 v251, s84, v251
    s_mul_i32 s90, s73, 11
    s_add_u32 s90, s90, s74
    s_mul_i32 s91, s73, 5
    s_add_u32 s91, s91, s74
    s_add_u32 s91, s91, 77
    s_cmp_lt_u32 s74, 11
    s_cselect_b32 s90, s90, s91
    s_lshl_b32 s91, s90, 7
    s_add_u32 s91, s91, 81920
    s_cmp_lt_u32 s90, 86
    s_cselect_b32 s84, 0, 0x7f000000
    v_or_b32 v252, s84, v252
    s_lshl4_add_u32 s84, s75, s76
    s_lshl_b32 s84, s84, 13
    s_mov_b32 s40, 0x8000
    s_mov_b32 s41, 0x10000
    s_mov_b32 s42, 0x18000
    v_lshlrev_b32 v4, 4, v0
    v_add_u32 v4, s84, v4
    s_mov_b64 s[48:49], s[14:15]
    s_mov_b32 s50, 0x400000
    s_mov_b32 s51, 0x20000
    s_mov_b64 s[60:61], s[18:19]
    s_mov_b32 s62, 1409024
    s_mov_b32 s63, 0x20000
    s_mov_b64 s[64:65], s[20:21]
    s_mov_b32 s66, 1409024
    s_mov_b32 s67, 0x20000
    s_mov_b64 s[68:69], s[22:23]
    s_mov_b32 s70, 1409024
    s_mov_b32 s71, 0x20000
    s_and_b32 s84, s72, 3
    s_lshl2_add_u32 s84, s74, s84
    s_mul_i32 s84, s84, 22016
    s_mul_i32 s85, s73, 352
    s_add_u32 s84, s84, s85
    v_mul_u32_u24 v246, 2752, v3
    v_lshl_add_u32 v246, v2, 4, v246
    v_add_u32 v246, s84, v246
    v_lshrrev_b32 v245, 3, v1
    v_mul_u32_u24 v245, 2752, v245
    v_and_b32 v13, 7, v1
    v_min_u32 v13, 5, v13
    v_lshl_add_u32 v245, v13, 4, v245
    v_add_u32 v245, s84, v245
    s_cmp_ge_u32 s72, 4
    s_cselect_b64 s[52:53], s[20:21], s[18:19]
    s_mov_b32 s54, 1409024
    s_mov_b32 s55, 0x20000
    s_mov_b32 s93, 11008
    ds_read_b64_tr_b16 v[16:17], v188 offset:0
    ds_read_b64_tr_b16 v[18:19], v188 offset:16384
    ds_read_b64_tr_b16 v[20:21], v188 offset:256
    ds_read_b64_tr_b16 v[22:23], v188 offset:16640
    ds_read_b64_tr_b16 v[24:25], v188 offset:512
    ds_read_b64_tr_b16 v[26:27], v188 offset:16896
    ds_read_b64_tr_b16 v[28:29], v188 offset:768
    ds_read_b64_tr_b16 v[30:31], v188 offset:17152
    ds_read_b64_tr_b16 v[32:33], v188 offset:32768
    ds_read_b64_tr_b16 v[34:35], v188 offset:49152
    ds_read_b64_tr_b16 v[36:37], v188 offset:33024
    ds_read_b64_tr_b16 v[38:39], v188 offset:49408
    ds_read_b64_tr_b16 v[40:41], v188 offset:33280
    ds_read_b64_tr_b16 v[42:43], v188 offset:49664
    ds_read_b64_tr_b16 v[44:45], v188 offset:33536
    ds_read_b64_tr_b16 v[46:47], v188 offset:49920
    s_waitcnt vmcnt(4)
    s_barrier
    s_mov_b32 m0, s30
    s_nop 0
    buffer_load_dwordx4 v196, s[36:39], 0 offen sc1 lds
    buffer_load_dwordx4 v197, s[36:39], 0 offen offset:1024 sc1 lds
    s_lshr_b32 s84, s72, 1
    s_cmp_eq_u32 s84, 2
    s_cbranch_scc0 L_ar_5
    ds_read_b128 v[80:83], v180 offset:0
    ds_read_b128 v[84:87], v181 offset:0
    ds_read_b128 v[88:91], v182 offset:0
    ds_read_b128 v[92:95], v183 offset:0
    ds_read_b128 v[96:99], v180 offset:256
    ds_read_b128 v[100:103], v181 offset:256
    ds_read_b128 v[104:107], v182 offset:256
    ds_read_b128 v[108:111], v183 offset:256
    ds_read_b128 v[112:115], v180 offset:512
    ds_read_b128 v[116:119], v181 offset:512
    ds_read_b128 v[120:123], v182 offset:512
    ds_read_b128 v[124:127], v183 offset:512
    ds_read_b128 v[128:131], v180 offset:768
    ds_read_b128 v[132:135], v181 offset:768
    ds_read_b128 v[136:139], v182 offset:768
    ds_read_b128 v[140:143], v183 offset:768
L_ar_5:
    ds_read_b64_tr_b16 v[48:49], v189 offset:0
    ds_read_b64_tr_b16 v[50:51], v189 offset:16384
    ds_read_b64_tr_b16 v[52:53], v189 offset:256
    ds_read_b64_tr_b16 v[54:55], v189 offset:16640
    ds_read_b64_tr_b16 v[56:57], v189 offset:512
    ds_read_b64_tr_b16 v[58:59], v189 offset:16896
    ds_read_b64_tr_b16 v[60:61], v189 offset:768
    ds_read_b64_tr_b16 v[62:63], v189 offset:17152
    s_waitcnt vmcnt(2)
    s_barrier
    s_lshr_b32 s84, s72, 1
    s_cmp_eq_u32 s84, 3
    s_cbranch_scc0 L_ar_6
    ds_read_b128 v[80:83], v180 offset:0
    ds_read_b128 v[84:87], v181 offset:0
    ds_read_b128 v[88:91], v182 offset:0
    ds_read_b128 v[92:95], v183 offset:0
    ds_read_b128 v[96:99], v180 offset:256
    ds_read_b128 v[100:103], v181 offset:256
    ds_read_b128 v[104:107], v182 offset:256
    ds_read_b128 v[108:111], v183 offset:256
    ds_read_b128 v[112:115], v180 offset:512
    ds_read_b128 v[116:119], v181 offset:512
    ds_read_b128 v[120:123], v182 offset:512
    ds_read_b128 v[124:127], v183 offset:512
    ds_read_b128 v[128:131], v180 offset:768
    ds_read_b128 v[132:135], v181 offset:768
    ds_read_b128 v[136:139], v182 offset:768
    ds_read_b128 v[140:143], v183 offset:768
L_ar_6:
    buffer_load_dwordx4 v[200:203], v4, s[48:51], 0 offen
    buffer_load_dwordx4 v[204:207], v4, s[48:51], s40 offen
    s_waitcnt vmcnt(2)
L_qk_7:
    s_barrier
    ds_read_b128 v[64:67], v184 offset:0
    ds_read_b128 v[68:71], v185 offset:0
    ds_read_b128 v[72:75], v186 offset:0
    ds_read_b128 v[76:79], v187 offset:0
    ds_read_b128 v[216:219], v184 offset:256
    s_waitcnt lgkmcnt(4)
    v_mfma_f32_16x16x32_bf16 v[144:147], v[80:83], v[64:67], 0
    s_cmp_ge_u32 s72, 4
    s_cbranch_scc1 L_bh_10
    buffer_load_dwordx4 v[240:243], v246, s[52:55], 0 offen
    buffer_load_dwordx4 v[240:243], v246, s[52:55], s93 offen
    buffer_load_dwordx4 v[240:243], v245, s[52:55], 0 offen offset:256
L_bh_10:
    ds_read_b128 v[220:223], v185 offset:256
    s_waitcnt lgkmcnt(4)
    v_mfma_f32_16x16x32_bf16 v[144:147], v[84:87], v[68:71], v[144:147]
    ds_read_b128 v[64:67], v186 offset:256
    s_waitcnt lgkmcnt(4)
    v_mfma_f32_16x16x32_bf16 v[144:147], v[88:91], v[72:75], v[144:147]
    buffer_load_dwordx4 v[208:211], v4, s[48:51], s41 offen
    ds_read_b128 v[68:71], v187 offset:256
    s_waitcnt lgkmcnt(4)
    v_mfma_f32_16x16x32_bf16 v[144:147], v[92:95], v[76:79], v[144:147]
    ds_read_b128 v[72:75], v184 offset:512
    s_waitcnt lgkmcnt(4)
    v_mfma_f32_16x16x32_bf16 v[144:147], v[96:99], v[216:219], v[144:147]
    ds_read_b128 v[76:79], v185 offset:512
    s_waitcnt lgkmcnt(4)
    v_mfma_f32_16x16x32_bf16 v[144:147], v[100:103], v[220:223], v[144:147]
    ds_read_b128 v[216:219], v186 offset:512
    s_waitcnt lgkmcnt(4)
    v_mfma_f32_16x16x32_bf16 v[144:147], v[104:107], v[64:67], v[144:147]
    ds_read_b128 v[220:223], v187 offset:512
    s_waitcnt lgkmcnt(4)
    v_mfma_f32_16x16x32_bf16 v[144:147], v[108:111], v[68:71], v[144:147]
    ds_read_b128 v[64:67], v184 offset:768
    s_waitcnt lgkmcnt(4)
    v_mfma_f32_16x16x32_bf16 v[144:147], v[112:115], v[72:75], v[144:147]
    ds_read_b128 v[68:71], v185 offset:768
    s_waitcnt lgkmcnt(4)
    v_mfma_f32_16x16x32_bf16 v[144:147], v[116:119], v[76:79], v[144:147]
    ds_read_b128 v[72:75], v186 offset:768
    s_waitcnt lgkmcnt(4)
    v_mfma_f32_16x16x32_bf16 v[144:147], v[120:123], v[216:219], v[144:147]
    ds_read_b128 v[76:79], v187 offset:768
    s_waitcnt lgkmcnt(4)
    v_mfma_f32_16x16x32_bf16 v[144:147], v[124:127], v[220:223], v[144:147]
    s_waitcnt lgkmcnt(3)
    v_mfma_f32_16x16x32_bf16 v[144:147], v[128:131], v[64:67], v[144:147]
    s_waitcnt lgkmcnt(2)
    v_mfma_f32_16x16x32_bf16 v[144:147], v[132:135], v[68:71], v[144:147]
    s_waitcnt lgkmcnt(1)
    v_mfma_f32_16x16x32_bf16 v[144:147], v[136:139], v[72:75], v[144:147]
    s_waitcnt lgkmcnt(0)
    v_mfma_f32_16x16x32_bf16 v[144:147], v[140:143], v[76:79], v[144:147]
    s_nop 7
    v_maximum3_f32 v12, v144, v145, v146
    v_maximum3_f32 v12, v12, v147, v147
    v_mov_b32 v13, v12
    s_nop 1
    v_permlane16_swap_b32 v12, v13
    v_maximum3_f32 v12, v12, v13, v13
    v_mov_b32 v13, v12
    s_nop 1
    v_permlane32_swap_b32 v12, v13
    v_maximum3_f32 v12, v12, v13, v13
    ds_write_b32 v248, v12
    buffer_store_dword v247, v252, s[36:39], s91 offen sc1
    s_waitcnt lgkmcnt(0)
    s_barrier
    ds_read_b128 v[148:151], v249
    ds_read_b128 v[152:155], v249 offset:16
    ds_read_b64_tr_b16 v[80:81], v189 offset:32768
    ds_read_b64_tr_b16 v[82:83], v189 offset:49152
    ds_read_b64_tr_b16 v[84:85], v189 offset:33024
    ds_read_b64_tr_b16 v[86:87], v189 offset:49408
    ds_read_b64_tr_b16 v[88:89], v189 offset:33280
    ds_read_b64_tr_b16 v[90:91], v189 offset:49664
    ds_read_b64_tr_b16 v[92:93], v189 offset:33536
    ds_read_b64_tr_b16 v[94:95], v189 offset:49920
    s_waitcnt lgkmcnt(9)
    v_maximum3_f32 v12, v148, v149, v150
    s_waitcnt lgkmcnt(8)
    v_maximum3_f32 v13, v151, v152, v153
    v_maximum3_f32 v12, v154, v155, v12
    v_maximum3_f32 v14, v12, v13, v13
    v_sub_f32 v144, v144, v14
    v_sub_f32 v145, v145, v14
    v_sub_f32 v146, v146, v14
    v_sub_f32 v147, v147, v14
    v_cmp_u_f32 vcc, v14, v14
    v_exp_f32 v144, v144
    v_exp_f32 v145, v145
    v_exp_f32 v146, v146
    v_exp_f32 v147, v147
    s_cbranch_vccnz L_slow_9
L_cont_8:
    v_cvt_pk_bf16_f32 v12, v144, v145
    v_cvt_pk_bf16_f32 v13, v146, v147
    ds_write_b64 v250, v[12:13]
    s_waitcnt lgkmcnt(0)
    s_barrier
    ds_read_b128 v[148:151], v253 offset:0
    ds_read_b128 v[152:155], v253 offset:1024
    ds_read_b128 v[156:159], v253 offset:2048
    ds_read_b128 v[160:163], v253 offset:3072
    s_waitcnt lgkmcnt(3)
    v_mfma_f32_16x16x32_bf16 v[164:167], v[148:151], v[16:19], 0
    v_mfma_f32_16x16x32_bf16 v[168:171], v[148:151], v[20:23], 0
    s_waitcnt lgkmcnt(2)
    v_mfma_f32_16x16x32_bf16 v[164:167], v[152:155], v[32:35], v[164:167]
    v_mfma_f32_16x16x32_bf16 v[168:171], v[152:155], v[36:39], v[168:171]
    s_waitcnt lgkmcnt(1)
    v_mfma_f32_16x16x32_bf16 v[164:167], v[156:159], v[48:51], v[164:167]
    v_mfma_f32_16x16x32_bf16 v[168:171], v[156:159], v[52:55], v[168:171]
    s_waitcnt lgkmcnt(0)
    v_mfma_f32_16x16x32_bf16 v[164:167], v[160:163], v[80:83], v[164:167]
    v_mfma_f32_16x16x32_bf16 v[168:171], v[160:163], v[84:87], v[168:171]
    v_mfma_f32_16x16x32_bf16 v[172:175], v[148:151], v[24:27], 0
    v_mfma_f32_16x16x32_bf16 v[176:179], v[148:151], v[28:31], 0
    v_mfma_f32_16x16x32_bf16 v[172:175], v[152:155], v[40:43], v[172:175]
    v_mfma_f32_16x16x32_bf16 v[176:179], v[152:155], v[44:47], v[176:179]
    v_mfma_f32_16x16x32_bf16 v[172:175], v[156:159], v[56:59], v[172:175]
    v_mfma_f32_16x16x32_bf16 v[176:179], v[156:159], v[60:63], v[176:179]
    v_mfma_f32_16x16x32_bf16 v[172:175], v[160:163], v[88:91], v[172:175]
    v_mfma_f32_16x16x32_bf16 v[176:179], v[160:163], v[92:95], v[176:179]
    v_cvt_pk_bf16_f32 v232, v164, v168
    v_cvt_pk_bf16_f32 v234, v165, v169
    v_cvt_pk_bf16_f32 v236, v166, v170
    v_cvt_pk_bf16_f32 v238, v167, v171
    s_nop 3
    v_cvt_pk_bf16_f32 v233, v172, v176
    buffer_store_dwordx2 v[232:233], v251, s[36:39], 0 offen sc1
    v_cvt_pk_bf16_f32 v235, v173, v177
    buffer_store_dwordx2 v[234:235], v251, s[36:39], s56 offen sc1
    v_cvt_pk_bf16_f32 v237, v174, v178
    buffer_store_dwordx2 v[236:237], v251, s[36:39], s57 offen sc1
    v_cvt_pk_bf16_f32 v239, v175, v179
    buffer_store_dwordx2 v[238:239], v251, s[36:39], s58 offen sc1
    s_cmp_lg_u32 s72, 0
    s_cbranch_scc1 L_nol_11
    v_mov_b32 v144, 0x3f803f80
    v_mov_b32 v145, 0x3f803f80
    v_mov_b32 v146, 0x3f803f80
    v_mov_b32 v147, 0x3f803f80
    s_nop 1
    v_mfma_f32_16x16x32_bf16 v[164:167], v[144:147], v[148:151], 0
    v_mfma_f32_16x16x32_bf16 v[164:167], v[144:147], v[152:155], v[164:167]
    v_mfma_f32_16x16x32_bf16 v[164:167], v[144:147], v[156:159], v[164:167]
    v_mfma_f32_16x16x32_bf16 v[164:167], v[144:147], v[160:163], v[164:167]
    v_lshlrev_b32 v145, 10, v1
    s_nop 6
    v_mov_b32 v15, v164

L_nol_11:
    v_lshlrev_b32 v17, 12, v3
    v_lshl_or_b32 v17, v2, 3, v17
    s_lshl_b32 s84, s90, 14
    s_lshl_b32 s85, s72, 7
    s_add_u32 s84, s84, s85
    v_add_u32 v17, s84, v17
    s_mov_b32 s88, 0x05040100
    s_mov_b32 s89, 0x07060302
    s_barrier
    buffer_load_dwordx4 v[212:215], v4, s[48:51], s42 offen
    s_cmp_ge_u32 s74, 12
    s_cbranch_scc1 L_z_13
    buffer_load_dwordx2 v[24:25], v17, s[68:71], 0 offen offset:0  nt
    buffer_load_dwordx2 v[26:27], v17, s[68:71], 0 offen offset:1024  nt
    buffer_load_dwordx2 v[28:29], v17, s[68:71], 0 offen offset:2048  nt
    buffer_load_dwordx2 v[30:31], v17, s[68:71], 0 offen offset:3072  nt
    s_branch L_z_14
L_z_13:
    s_and_b32 s84, s72, 3
    s_lshl2_add_u32 s84, s74, s84
    s_sub_u32 s85, s74, 12
    s_lshl3_add_u32 s85, s85, s72
    s_lshl_b32 s85, s85, 1
    s_sub_u32 s84, s85, s84
    s_mul_i32 s84, s84, 22016
    v_add_u32 v246, s84, v246
    v_add_u32 v245, s84, v245
    s_mov_b64 s[52:53], s[20:21]
    s_mov_b32 s46, 22016
    s_mov_b32 s47, 33024
    buffer_load_dwordx4 v[240:243], v246, s[52:55], 0 offen offset:0
    buffer_load_dwordx4 v[240:243], v246, s[52:55], s93 offen offset:0
    s_waitcnt vmcnt(3)
L_z_14:
    s_cmp_lg_u32 s72, 0
    s_waitcnt vmcnt(5)
    s_barrier
    s_cbranch_scc1 L_nost_12
    s_mov_b64 exec, 0xffff
    buffer_atomic_swap_x2 v[14:15], v145, s[36:39], s59 offen sc1
    s_mov_b64 exec, -1
L_nost_12:
    s_cmp_ge_u32 s74, 12
    s_cbranch_scc0 L_z_15
    buffer_load_dwordx4 v[240:243], v245, s[52:55], 0 offen offset:256
    buffer_load_dwordx4 v[240:243], v246, s[52:55], s46 offen offset:0
    buffer_load_dwordx4 v[240:243], v246, s[52:55], s47 offen offset:0
    buffer_load_dwordx4 v[240:243], v245, s[52:55], s46 offen offset:256
L_z_15:
    s_cmp_ge_u32 s74, 14
    s_cbranch_scc1 L_red
    s_cmp_ge_u32 s90, 86
    s_cbranch_scc1 L_wdone

    v_lshrrev_b32 v16, 1, v1
    v_mul_u32_u24 v16, 2752, v16
    v_and_b32 v18, 1, v1
    v_lshl_add_u32 v16, v18, 4, v16
    s_lshl1_add_u32 s92, s90, s72
    s_and_b32 s92, s92, 7
    s_mul_i32 s44, s92, 176128
    s_lshl_b32 s45, s90, 5
    s_add_u32 s44, s44, s45
    s_add_u32 s45, s44, 88064
    s_lshl_b32 s86, s72, 12
    s_add_u32 m0, s86, 0
    s_nop 0
    buffer_load_dwordx4 v16, s[60:63], s44 offen  lds
    s_add_u32 m0, s86, 1024
    s_nop 0
    buffer_load_dwordx4 v16, s[60:63], s45 offen  lds
    s_barrier
    s_add_u32 m0, s86, 2048
    s_nop 0
    buffer_load_dwordx4 v16, s[64:67], s44 offen  lds
    s_add_u32 m0, s86, 3072
    s_nop 0
    buffer_load_dwordx4 v16, s[64:67], s45 offen  lds
    v_bfe_u32 v18, v1, 2, 2
    v_lshl_add_u32 v18, v3, 3, v18
    v_lshlrev_b32 v18, 5, v18
    v_and_b32 v19, 3, v1
    v_lshl_add_u32 v18, v19, 3, v18
    v_add_u32 v18, s86, v18
    s_lshl_b32 s85, s92, 7
    s_add_u32 s85, s85, 147456
    v_lshl_add_u32 v19, v3, 4, s85
    ds_read_b128 v[32:35], v19
    ds_read_b128 v[36:39], v19 offset:64
    v_and_b32 v20, 31, v1
    v_mul_u32_u24 v20, 48, v20
    v_lshrrev_b32 v21, 5, v1
    v_lshl_add_u32 v21, v21, 4, v20
    v_add_u32 v21, 65536, v21
    s_lshl2_add_u32 s85, s72, 65536
    v_add_u32 v20, s85, v20
    s_lshl_b32 s85, s72, 5
    s_add_u32 s85, s85, 73728
    v_lshl_add_u32 v22, v2, 1, s85
    v_lshl_add_u32 v23, v3, 3, s85
    v_lshrrev_b32 v72, 3, v2
    v_lshlrev_b32 v72, 15, v72
    v_and_b32 v73, 7, v2
    v_lshl_or_b32 v72, v73, 4, v72
    s_lshl_b32 s85, s72, 16
    v_add_u32 v72, s85, v72
    s_bfe_u32 s84, s90, 0x30003
    s_lshl_b32 s84, s84, 11
    s_add_u32 s84, s84, 851968
    s_cmp_eq_u32 s72, 0
    s_cselect_b32 s84, s84, 0x7f000000
    v_lshl_add_u32 v74, v1, 7, s84
    v_mov_b32 v75, 1
    s_waitcnt vmcnt(4)
    v_perm_b32 v64, v26, v24, s88
    v_perm_b32 v65, v30, v28, s88
    v_perm_b32 v66, v26, v24, s89
    v_perm_b32 v67, v30, v28, s89
    v_perm_b32 v68, v27, v25, s88
    v_perm_b32 v69, v31, v29, s88
    v_perm_b32 v70, v27, v25, s89
    v_perm_b32 v71, v31, v29, s89
    s_waitcnt vmcnt(3)
    ds_read_b64_tr_b16 v[40:41], v18 offset:0
    ds_read_b64_tr_b16 v[42:43], v18 offset:128
    s_waitcnt vmcnt(2)
    ds_read_b64_tr_b16 v[44:45], v18 offset:1024
    ds_read_b64_tr_b16 v[46:47], v18 offset:1152
    s_waitcnt vmcnt(1)
    ds_read_b64_tr_b16 v[48:49], v18 offset:2048
    ds_read_b64_tr_b16 v[50:51], v18 offset:2176
    s_waitcnt vmcnt(0)
    ds_read_b64_tr_b16 v[52:53], v18 offset:3072
    ds_read_b64_tr_b16 v[54:55], v18 offset:3200
    s_waitcnt lgkmcnt(2)
    v_mfma_f32_16x16x32_bf16 v[56:59], v[32:35], v[40:43], 0
    v_mfma_f32_16x16x32_bf16 v[60:63], v[32:35], v[48:51], 0
    v_mfma_f32_16x16x32_bf16 v[56:59], v[36:39], v[44:47], v[56:59]
    s_waitcnt lgkmcnt(0)
    v_mfma_f32_16x16x32_bf16 v[60:63], v[36:39], v[52:55], v[60:63]
    s_nop 7
    v_mov_b32_dpp v56, v60 quad_perm:[0,1,2,3] row_mask:0xa bank_mask:0xf
    ds_write_b32 v20, v56
    s_waitcnt lgkmcnt(0)
    s_barrier
    ds_read_b128 v[32:35], v21
    s_cmp_lg_u32 s72, 0
    s_cbranch_scc1 L_hs_16
    s_mov_b64 exec, 0xffff
    buffer_atomic_add v75, v74, s[36:39], 0 offen sc1
    s_mov_b64 exec, -1
L_hs_16:
    s_waitcnt lgkmcnt(0)
    v_add_f32 v32, v32, v33
    v_add_f32 v34, v34, v35
    v_add_f32 v33, v32, v34
    v_add_f32 v32, v32, v34
    s_nop 1
    v_permlane32_swap_b32 v32, v33
    v_add_f32 v32, v32, v33
    v_cvt_pk_bf16_f32 v32, v32, v32
    v_and_b32 v33, 0xffff0000, v32
    v_and_b32 v32, 0xffff0000, v32
    s_nop 1
    v_permlane16_swap_b32 v32, v33
    v_mul_f32 v32, v32, v33
    v_cvt_pk_bf16_f32 v32, v32, v32
    ds_write_b16 v22, v32
    ds_read_b64 v[40:41], v23
    s_waitcnt lgkmcnt(0)
    v_mfma_f32_16x16x16_bf16 v[44:47], v[40:41], v[64:65], 0
    v_mfma_f32_16x16x16_bf16 v[48:51], v[40:41], v[66:67], 0
    v_mfma_f32_16x16x16_bf16 v[52:55], v[40:41], v[68:69], 0
    v_mfma_f32_16x16x16_bf16 v[56:59], v[40:41], v[70:71], 0
    s_mov_b64 exec, 0xffff
    s_nop 4
    v_mov_b32 v45, v48
    v_mov_b32 v46, v52
    v_mov_b32 v47, v56
    buffer_store_dwordx4 v[44:47], v72, s[36:39], s91 offen sc1
    s_mov_b64 exec, -1
L_wdone:
    s_endpgm
L_red:
    s_lshl1_add_u32 s90, s73, s74
    s_sub_u32 s90, s90, 14
    s_lshl3_add_u32 s84, s90, s72
    s_lshl_b32 s84, s84, 7
    s_add_u32 s84, s84, 32768
    v_lshlrev_b32 v16, 14, v3
    v_lshl_or_b32 v16, v2, 3, v16
    v_add_u32 v16, s84, v16
    s_lshl_b32 s85, s90, 6
    v_and_b32 v21, 31, v1
    v_lshl_add_u32 v22, v21, 1, s85
    global_load_ushort v23, v22, s[4:5]

    s_waitcnt vmcnt(0)
    s_lshl_b32 s84, s90, 15
    s_add_u32 s84, s84, 65536
    s_add_u32 s85, s84, 0x2000
    s_add_u32 s86, s84, 0x4000
    v_lshlrev_b32 v16, 4, v0
    v_add_u32 v17, 0x2000, v16
    v_cmp_gt_u32 vcc, 176, v0
    v_mov_b32 v18, 0x7fffff00
    s_nop 0
    v_cndmask_b32 v17, v18, v17, vcc
    v_lshl_add_u32 v19, v2, 2, v3
    v_mul_u32_u24 v19, 48, v19
    s_lshl_b32 s92, s72, 2
    v_add_u32 v19, s92, v19
    v_mul_u32_u24 v20, 48, v1
    v_lshlrev_b32 v23, 16, v23
    v_cmp_gt_u32 vcc, 32, v1
    s_nop 1
    v_cndmask_b32 v23, 0, v23, vcc
    s_lshl4_add_u32 s88, s72, s90
    s_lshl_b32 s88, s88, 7
    s_add_u32 s88, s88, 851968
    v_mov_b32 v40, s88
    s_cmp_lt_u32 s72, 2
    s_cselect_b32 s89, 31, 23
    s_cmp_eq_u32 s72, 2
    s_cselect_b32 s89, 29, s89
    s_mov_b32 s87, 0
    s_mov_b64 exec, 1
    v_mov_b32 v41, 0
    buffer_atomic_add v41, v40, s[36:39], 0 offen sc0 sc1
    s_sleep 3
    v_mov_b32 v42, 0
    buffer_atomic_add v42, v40, s[36:39], 0 offen sc0 sc1
    s_sleep 3
    v_mov_b32 v43, 0
    buffer_atomic_add v43, v40, s[36:39], 0 offen sc0 sc1
    s_sleep 3
L_hp:
    v_mov_b32 v44, 0
    buffer_atomic_add v44, v40, s[36:39], 0 offen sc0 sc1
    s_waitcnt vmcnt(3)
    v_cmp_ne_u32 vcc, s89, v41
    s_nop 0
    s_cbranch_vccz L_hpok
    s_sleep 3
    v_mov_b32 v41, 0
    buffer_atomic_add v41, v40, s[36:39], 0 offen sc0 sc1
    s_waitcnt vmcnt(3)
    v_cmp_ne_u32 vcc, s89, v42
    s_nop 0
    s_cbranch_vccz L_hpok
    s_sleep 3
    v_mov_b32 v42, 0
    buffer_atomic_add v42, v40, s[36:39], 0 offen sc0 sc1
    s_waitcnt vmcnt(3)
    v_cmp_ne_u32 vcc, s89, v43
    s_nop 0
    s_cbranch_vccz L_hpok
    s_sleep 3
    v_mov_b32 v43, 0
    buffer_atomic_add v43, v40, s[36:39], 0 offen sc0 sc1
    s_waitcnt vmcnt(3)
    v_cmp_ne_u32 vcc, s89, v44
    s_nop 0
    s_cbranch_vccz L_hpok
    s_sleep 3
    s_add_u32 s87, s87, 1
    s_cmp_lt_u32 s87, 32768
    s_cbranch_scc1 L_hp
L_hpok:
    s_mov_b64 exec, -1
    buffer_load_dwordx4 v[64:67], v16, s[36:39], s86 offen sc1
    buffer_load_dwordx4 v[68:71], v17, s[36:39], s86 offen sc1
    buffer_load_dwordx4 v[72:75], v16, s[36:39], s84 offen sc1
    buffer_load_dwordx4 v[76:79], v16, s[36:39], s85 offen sc1
    s_mov_b32 s87, 0
L_rsum:
    s_waitcnt vmcnt(2)
    v_add_f32 v24, v64, v68
    v_add_f32 v26, v66, v70
    v_add_f32 v25, v65, v69
    v_add_f32 v27, v67, v71
    s_waitcnt vmcnt(1)
    v_add_f32 v24, v24, v72
    v_add_f32 v26, v26, v74
    v_add_f32 v25, v25, v73
    v_add_f32 v27, v27, v75
    s_waitcnt vmcnt(0)
    v_add_f32 v24, v24, v76
    v_add_f32 v26, v26, v78
    v_add_f32 v25, v25, v77
    v_add_f32 v27, v27, v79
    v_permlane32_swap_b32 v24, v26
    s_nop 0
    v_permlane32_swap_b32 v25, v27
    v_add_f32 v24, v24, v26
    v_add_f32 v25, v25, v27
    s_cmp_lg_u32 s72, 0
    s_nop 0
    v_permlane16_swap_b32 v24, v25
    v_cmp_u_f32 vcc, v24, v25
    v_add_f32 v24, v24, v25
    ds_write_b32 v19, v24
    s_cbranch_vccnz L_rchk
L_rgo:

    s_waitcnt lgkmcnt(0)
    s_barrier
    s_cbranch_scc1 L_rdone
    ds_read_b128 v[32:35], v20
    ds_read_b128 v[36:39], v20 offset:16
    s_waitcnt lgkmcnt(1)
    v_add_f32 v32, v32, v33
    v_add_f32 v34, v34, v35
    v_add_f32 v32, v32, v23
    s_waitcnt lgkmcnt(0)
    v_add_f32 v36, v36, v37
    v_add_f32 v38, v38, v39
    v_add_f32 v32, v32, v34
    v_add_f32 v36, v36, v38
    v_add_f32 v33, v32, v36
    v_add_f32 v32, v32, v36
    s_nop 1
    v_permlane32_swap_b32 v32, v33
    s_mov_b32 exec_hi, 0
    v_add_f32 v32, v32, v33
    v_cvt_pk_bf16_f32 v32, v32, v32
    global_store_short v22, v32, s[24:25]
    s_mov_b64 exec, -1
L_rdone:
    s_endpgm
L_rchk:
    v_max3_u32 v12, v64, v65, v66
    v_max3_u32 v13, v67, v68, v69
    v_max3_u32 v12, v70, v71, v12
    v_max3_u32 v13, v72, v73, v13
    v_max3_u32 v12, v74, v75, v12
    v_max3_u32 v13, v76, v77, v13
    v_max3_u32 v12, v78, v79, v12
    v_max_u32 v12, v12, v13
    v_cmp_eq_u32 vcc, -1, v12
    s_nop 0
    s_cbranch_vccz L_rgo
    buffer_load_dwordx4 v[64:67], v16, s[36:39], s86 offen sc1
    buffer_load_dwordx4 v[68:71], v17, s[36:39], s86 offen sc1
    buffer_load_dwordx4 v[72:75], v16, s[36:39], s84 offen sc1
    buffer_load_dwordx4 v[76:79], v16, s[36:39], s85 offen sc1
    s_add_u32 s87, s87, 1
    s_cmp_lt_u32 s87, 32768
    s_cbranch_scc1 L_rsum
    s_waitcnt vmcnt(0)
    s_cmp_lg_u32 s72, 0
    s_branch L_rgo
L_A:
    s_mov_b64 s[36:37], s[28:29]
    s_mov_b32 s38, 5242880
    s_mov_b32 s39, 0x20000
    s_mov_b64 s[32:33], s[6:7]
    s_mov_b32 s34, 0x1000000
    s_mov_b32 s35, 0x20000
    s_cmp_lg_u32 s74, 0
    s_cbranch_scc1 L_nojan
    v_mov_b32 v8, -1
    v_mov_b32 v9, -1
    v_mov_b32 v10, -1
    v_mov_b32 v11, -1
    v_lshlrev_b32 v12, 4, v0
    s_lshl_b32 s84, s73, 13
    buffer_store_dwordx4 v[8:11], v12, s[36:39], s84 offen sc1
    v_lshlrev_b32 v13, 2, v0
    s_lshl_b32 s85, s73, 11
    s_add_u32 s85, s85, 851968
    buffer_store_dword v8, v13, s[36:39], s85 offen sc1
    s_branch L_jan1
L_nojan:
    buffer_load_dwordx4 v[24:27], v6, s[40:43], s79 offen
    buffer_load_dwordx4 v[28:31], v6, s[40:43], s80 offen
L_jan1:
    s_barrier
    buffer_load_dwordx4 v[32:35], v6, s[44:47], 0 offen
    buffer_load_dwordx4 v[36:39], v6, s[44:47], s78 offen
    buffer_load_dwordx4 v[40:43], v6, s[44:47], s79 offen
    s_and_b32 s84, s72, 1
    s_bfe_u32 s85, s72, 0x10001
    s_lshl3_add_u32 s84, s84, s85
    s_lshl_b32 s84, s84, 4
    v_xor_b32 v224, s84, v5
    s_lshl_b32 s82, s72, 14
    s_lshl_b32 s92, s72, 12
    s_lshl_b32 s83, s77, 15
    s_add_u32 s83, s83, s92
    v_xor_b32 v225, 32, v224
    v_xor_b32 v226, 64, v224
    v_xor_b32 v227, 96, v224
    v_and_b32 v180, 7, v2
    v_lshrrev_b32 v181, 3, v2
    v_lshl_or_b32 v180, v180, 1, v181
    v_lshlrev_b32 v181, 1, v3
    v_xor_b32 v180, v180, v181
    v_lshlrev_b32 v180, 4, v180
    v_lshl_or_b32 v180, v2, 10, v180
    s_lshl_b32 s84, s72, 14
    v_add_u32 v184, 131072, v180
    v_add_u32 v180, s84, v180
    v_xor_b32 v181, 16, v180
    v_xor_b32 v185, 16, v184
    v_xor_b32 v182, 128, v180
    v_xor_b32 v186, 128, v184
    v_xor_b32 v183, 144, v180
    v_xor_b32 v187, 144, v184
    v_lshrrev_b32 v192, 2, v1
    v_and_b32 v188, 7, v192
    v_lshrrev_b32 v189, 3, v192
    v_lshl_or_b32 v188, v188, 1, v189
    v_bfe_u32 v189, v1, 1, 1
    s_lshl_b32 s84, s72, 1
    v_or_b32 v189, s84, v189
    v_xor_b32 v188, v188, v189
    v_lshlrev_b32 v188, 4, v188
    v_lshl_or_b32 v188, v192, 10, v188
    v_and_b32 v189, 1, v1
    v_lshl_or_b32 v188, v189, 3, v188
    v_add_u32 v189, 0x10000, v188
    s_lshr_b32 s84, s72, 1
    s_and_b32 s85, s72, 1
    s_lshl_b32 s86, s84, 10
    s_lshl3_add_u32 s86, s85, s86
    s_add_u32 s86, s86, 151552
    v_add_u32 v250, s86, v5
    v_add_u32 v253, 151552, v5
    v_lshlrev_b32 v251, 19, v3
    v_lshl_or_b32 v251, v2, 3, v251
    s_lshl_b32 s84, s84, 15
    s_lshl_b32 s85, s85, 7
    s_add_u32 s84, s84, s85
    s_lshl_b32 s85, s77, 8
    s_add_u32 s84, s84, s85
    s_add_u32 s84, s84, 3145728
    v_add_u32 v251, s84, v251
    s_cmp_lg_u32 s74, 0
    s_cbranch_scc1 L_nojan2
    s_waitcnt vmcnt(3)
    s_barrier
    s_cmp_lg_u32 s72, 0
    s_cbranch_scc1 L_nojan2
    v_mov_b32 v12, 1

    s_lshl_b32 s84, s73, 2
    v_mov_b32 v13, s84
    s_mov_b64 exec, 1
    global_store_dword v13, v12, s[26:27] sc1
    s_mov_b64 exec, -1
L_nojan2:
    s_and_b32 s84, s72, 3
    s_lshr_b32 s85, s72, 2
    s_lshl2_add_u32 s84, s84, s85
    s_lshl_b32 s84, s84, 4
    v_xor_b32 v196, s84, v5
    s_lshl_b32 s30, s72, 11
    s_add_u32 s84, s30, 16384
    v_add_u32 v196, s84, v196
    v_xor_b32 v197, 32, v196
    s_add_u32 s30, s30, 131072
    s_mov_b32 s31, 0
    v_lshlrev_b32 v249, 5, v2
    v_add_u32 v249, 148992, v249
    s_lshl_b32 s84, s72, 2
    v_add_u32 v248, s84, v249
    v_lshrrev_b32 v252, 5, v0
    v_and_b32 v4, 31, v0
    v_lshlrev_b32 v252, 15, v252
    v_lshl_or_b32 v252, v4, 2, v252
    v_mov_b32 v247, -1
    s_mov_b32 s56, 0x20000
    s_mov_b32 s57, 0x40000
    s_mov_b32 s58, 0x60000
    s_lshl_b32 s59, s77, 3
    s_add_u32 s59, s59, 49152
    buffer_load_dwordx4 v[44:47], v6, s[44:47], s80 offen
    s_mov_b64 s[40:41], s[14:15]
    s_mov_b64 s[44:45], s[12:13]
    s_barrier
    s_add_u32 m0, s92, 0
    s_nop 0
    buffer_load_dwordx4 v224, s[32:35], s83 offen offset:0  lds
    buffer_load_dwordx4 v225, s[32:35], s83 offen offset:1024  lds
    buffer_load_dwordx4 v226, s[32:35], s83 offen offset:2048  lds
    buffer_load_dwordx4 v227, s[32:35], s83 offen offset:3072  lds
    s_barrier
    s_add_u32 m0, s92, 32768
    s_add_u32 s83, s83, 4194304
    buffer_load_dwordx4 v224, s[32:35], s83 offen offset:0  lds
    buffer_load_dwordx4 v225, s[32:35], s83 offen offset:1024  lds
    buffer_load_dwordx4 v226, s[32:35], s83 offen offset:2048  lds
    buffer_load_dwordx4 v227, s[32:35], s83 offen offset:3072  lds
    s_barrier
    s_load_dwordx8 s[64:71], s[26:27], 0
    s_add_u32 m0, s92, 65536
    s_add_u32 s83, s83, 4194304
    buffer_load_dwordx4 v224, s[32:35], s83 offen offset:0  lds
    buffer_load_dwordx4 v225, s[32:35], s83 offen offset:1024  lds
    buffer_load_dwordx4 v226, s[32:35], s83 offen offset:2048  lds
    buffer_load_dwordx4 v227, s[32:35], s83 offen offset:3072  lds
    s_waitcnt lgkmcnt(0)
    s_and_b64 s[64:65], s[64:65], s[66:67]
    s_and_b64 s[68:69], s[68:69], s[70:71]
    s_and_b64 s[64:65], s[64:65], s[68:69]
    s_mov_b32 s87, 0
    s_and_b32 s64, s64, s65
    s_cbranch_scc1 L_rdyok_18
    v_and_b32 v14, 7, v1
    v_lshlrev_b32 v14, 2, v14
L_rdy_17:
    global_load_dword v13, v14, s[26:27] sc1
    s_add_u32 s87, s87, 1
    s_waitcnt vmcnt(0)
    v_cmp_eq_u32 vcc, 0, v13
    s_cmp_lt_u32 s87, 32768
    s_cbranch_vccz L_rdyok_18
    s_cbranch_scc1 L_rdy_17
L_rdyok_18:
    s_barrier
    s_add_u32 m0, s92, 98304
    s_add_u32 s83, s83, 4194304
    buffer_load_dwordx4 v224, s[32:35], s83 offen offset:0  lds
    buffer_load_dwordx4 v225, s[32:35], s83 offen offset:1024  lds
    buffer_load_dwordx4 v226, s[32:35], s83 offen offset:2048  lds
    buffer_load_dwordx4 v227, s[32:35], s83 offen offset:3072  lds
    s_waitcnt vmcnt(8)
    s_barrier
    s_cmp_lt_u32 s72, 4
    s_cbranch_scc0 L_ar_19
    ds_read_b128 v[80:83], v180 offset:0
    ds_read_b128 v[84:87], v181 offset:0
    ds_read_b128 v[88:91], v182 offset:0
    ds_read_b128 v[92:95], v183 offset:0
    ds_read_b128 v[96:99], v180 offset:256
    ds_read_b128 v[100:103], v181 offset:256
    ds_read_b128 v[104:107], v182 offset:256
    ds_read_b128 v[108:111], v183 offset:256
    ds_read_b128 v[112:115], v180 offset:512
    ds_read_b128 v[116:119], v181 offset:512
    ds_read_b128 v[120:123], v182 offset:512
    ds_read_b128 v[124:127], v183 offset:512
    ds_read_b128 v[128:131], v180 offset:768
    ds_read_b128 v[132:135], v181 offset:768
    ds_read_b128 v[136:139], v182 offset:768
    ds_read_b128 v[140:143], v183 offset:768
L_ar_19:
    s_lshl2_add_u32 s90, s75, s76
    s_lshl_b32 s91, s90, 7
    s_add_u32 s91, s91, 65536
    v_lshlrev_b32 v4, 20, v3
    v_lshl_or_b32 v4, v2, 4, v4
    s_lshr_b32 s84, s72, 1
    s_lshl2_add_u32 s84, s76, s84
    s_lshl_b32 s84, s84, 16
    s_and_b32 s85, s72, 1
    s_lshl_b32 s85, s85, 13
    s_add_u32 s84, s84, s85
    s_lshl_b32 s85, s75, 8
    s_add_u32 s84, s84, s85
    v_add_u32 v4, s84, v4
    v_lshlrev_b32 v240, 1, v3
    v_xor_b32 v240, v240, v2
    v_lshlrev_b32 v240, 4, v240
    v_lshl_or_b32 v240, v3, 8, v240
    s_lshl_b32 s84, s72, 12
    s_add_u32 s84, s84, 131072
    v_add_u32 v240, s84, v240
    v_xor_b32 v241, 0x80, v240
    v_and_b32 v242, 7, v1
    v_lshlrev_b32 v243, 1, v3
    v_xor_b32 v242, v242, v243
    v_lshlrev_b32 v242, 4, v242
    v_lshrrev_b32 v243, 3, v1
    v_lshl_or_b32 v242, v243, 10, v242
    s_lshl_b32 s84, s72, 7
    s_lshl_b32 s85, s75, 17
    s_add_u32 s84, s84, s85
    v_add_u32 v242, s84, v242
    s_lshl_b32 s84, s90, 15
    v_lshlrev_b32 v244, 4, v0
    v_add_u32 v244, s84, v244
    s_mov_b32 s88, 0x8000
    s_mov_b32 s89, 0xc000

    s_lshl_b32 s84, s72, 12
    s_lshl_b32 s61, s90, 15
    s_add_u32 s61, s61, s84
    s_add_u32 s61, s61, 1048576
    v_and_b32 v13, 1, v2
    v_lshlrev_b32 v13, 4, v13
    s_mov_b32 s84, 0x00030003
    s_mov_b32 s85, 0x00030003
    s_mov_b32 s86, 0xffff
    v_lshlrev_b32 v13, v13, s86
    v_cndmask_b32 v228, 0, v13, s[84:85]
    s_lshl_b64 s[84:85], s[84:85], 2
    v_cndmask_b32 v229, 0, v13, s[84:85]
    s_lshl_b64 s[84:85], s[84:85], 2
    v_cndmask_b32 v230, 0, v13, s[84:85]
    s_lshl_b64 s[84:85], s[84:85], 2
    v_cndmask_b32 v231, 0, v13, s[84:85]
    s_mul_i32 s86, s72, 16416
    v_lshrrev_b32 v12, 1, v3
    v_lshlrev_b32 v191, 9, v12
    v_and_b32 v12, 1, v3
    v_lshl_add_u32 v191, v12, 2, v191
    v_lshl_add_u32 v191, v2, 3, v191
    v_add_u32 v191, s86, v191
    s_add_u32 s86, s86, 1024
    v_lshl_add_u32 v245, v1, 3, s86
    v_lshl_add_u32 v246, v3, 1, v2
    v_and_b32 v246, 7, v246
    v_mul_u32_u24 v246, 16416, v246
    v_lshl_add_u32 v246, v2, 3, v246
    s_add_u32 s86, s86, 512
    v_and_b32 v198, 3, v1
    v_lshlrev_b32 v198, 4, v198
    v_and_b32 v12, 12, v1
    v_or_b32 v198, v198, v12
    v_lshl_or_b32 v198, v3, 6, v198
    v_add_u32 v198, s86, v198
    v_lshl_add_u32 v7, v3, 4, s86
    s_lshl3_add_u32 s86, s75, s72
    s_lshl_b32 s86, s86, 7
    s_add_u32 s86, s86, 32768
    v_lshl_add_u32 v243, v1, 3, s86
    v_and_b32 v13, 1, v2
    v_mul_u32_u24 v190, 0xaaaa, v13
    v_add_u32 v190, 0x4444, v190
    v_lshlrev_b32 v14, 4, v3
    v_lshl_add_u32 v14, v13, 7, v14
    v_lshrrev_b32 v12, 1, v2
    v_mul_u32_u24 v192, 16416, v12
    v_add_u32 v192, v192, v14
    v_and_b32 v193, 1, v12
    v_lshlrev_b32 v193, 7, v193
    v_lshl_add_u32 v193, v13, 1, v193
    v_lshrrev_b32 v12, 2, v2
    v_lshl_add_u32 v193, v12, 3, v193
    v_mul_u32_u24 v194, 288, v12
    v_add_u32 v194, v194, v14
    v_add_u32 v194, 2048, v194
    v_mul_u32_u24 v13, 288, v3
    v_add_u32 v193, v193, v13
    s_lshr_b32 s84, s72, 1
    s_lshl_b32 s84, s84, 5
    s_and_b32 s85, s72, 1
    s_lshl2_add_u32 s84, s85, s84
    s_add_u32 s84, s84, 2048
    v_add_u32 v193, s84, v193
    v_lshrrev_b32 v12, 2, v1
    v_bfe_u32 v13, v1, 1, 1
    v_and_b32 v14, 1, v1
    v_lshlrev_b32 v14, 3, v14
    v_and_b32 v195, 6, v12
    v_or_b32 v195, v195, v13
    v_lshl_or_b32 v195, v195, 4, v14
    v_lshl_or_b32 v195, v12, 7, v195
    v_add_u32 v195, s82, v195
    v_and_b32 v199, 7, v12
    v_xor_b32 v199, s72, v199
    v_lshl_or_b32 v199, v199, 1, v13
    v_lshl_or_b32 v199, v199, 4, v14
    v_lshl_or_b32 v199, v12, 8, v199
    v_add_u32 v199, 131072, v199
    ds_read_b64_tr_b16 v[16:17], v188 offset:0
    ds_read_b64_tr_b16 v[18:19], v188 offset:16384
    ds_read_b64_tr_b16 v[20:21], v188 offset:256
    ds_read_b64_tr_b16 v[22:23], v188 offset:16640
    ds_read_b64_tr_b16 v[24:25], v188 offset:512
    ds_read_b64_tr_b16 v[26:27], v188 offset:16896
    ds_read_b64_tr_b16 v[28:29], v188 offset:768
    ds_read_b64_tr_b16 v[30:31], v188 offset:17152
    ds_read_b64_tr_b16 v[32:33], v188 offset:32768
    ds_read_b64_tr_b16 v[34:35], v188 offset:49152
    ds_read_b64_tr_b16 v[36:37], v188 offset:33024
    ds_read_b64_tr_b16 v[38:39], v188 offset:49408
    ds_read_b64_tr_b16 v[40:41], v188 offset:33280
    ds_read_b64_tr_b16 v[42:43], v188 offset:49664
    ds_read_b64_tr_b16 v[44:45], v188 offset:33536
    ds_read_b64_tr_b16 v[46:47], v188 offset:49920
    s_waitcnt vmcnt(4)
    s_barrier
    s_mov_b32 m0, s30
    s_nop 0
    buffer_load_dwordx4 v196, s[36:39], 0 offen sc1 lds
    buffer_load_dwordx4 v197, s[36:39], 0 offen offset:1024 sc1 lds
    s_barrier
    buffer_load_dwordx4 v[200:203], v4, s[44:47], 0 offen  nt
    buffer_load_dwordx4 v[204:207], v4, s[44:47], s79 offen  nt
    s_lshr_b32 s84, s72, 1
    s_cmp_eq_u32 s84, 2
    s_cbranch_scc0 L_ar_20
    ds_read_b128 v[80:83], v180 offset:0
    ds_read_b128 v[84:87], v181 offset:0
    ds_read_b128 v[88:91], v182 offset:0
    ds_read_b128 v[92:95], v183 offset:0
    ds_read_b128 v[96:99], v180 offset:256
    ds_read_b128 v[100:103], v181 offset:256
    ds_read_b128 v[104:107], v182 offset:256
    ds_read_b128 v[108:111], v183 offset:256
    ds_read_b128 v[112:115], v180 offset:512
    ds_read_b128 v[116:119], v181 offset:512
    ds_read_b128 v[120:123], v182 offset:512
    ds_read_b128 v[124:127], v183 offset:512
    ds_read_b128 v[128:131], v180 offset:768
    ds_read_b128 v[132:135], v181 offset:768
    ds_read_b128 v[136:139], v182 offset:768
    ds_read_b128 v[140:143], v183 offset:768
L_ar_20:
    ds_read_b64_tr_b16 v[48:49], v189 offset:0
    ds_read_b64_tr_b16 v[50:51], v189 offset:16384
    ds_read_b64_tr_b16 v[52:53], v189 offset:256
    ds_read_b64_tr_b16 v[54:55], v189 offset:16640
    ds_read_b64_tr_b16 v[56:57], v189 offset:512
    ds_read_b64_tr_b16 v[58:59], v189 offset:16896
    ds_read_b64_tr_b16 v[60:61], v189 offset:768
    ds_read_b64_tr_b16 v[62:63], v189 offset:17152
    s_waitcnt vmcnt(4)
    s_barrier
    s_lshr_b32 s84, s72, 1
    s_cmp_eq_u32 s84, 3
    s_cbranch_scc0 L_ar_21
    ds_read_b128 v[80:83], v180 offset:0
    ds_read_b128 v[84:87], v181 offset:0
    ds_read_b128 v[88:91], v182 offset:0
    ds_read_b128 v[92:95], v183 offset:0
    ds_read_b128 v[96:99], v180 offset:256
    ds_read_b128 v[100:103], v181 offset:256
    ds_read_b128 v[104:107], v182 offset:256
    ds_read_b128 v[108:111], v183 offset:256
    ds_read_b128 v[112:115], v180 offset:512
    ds_read_b128 v[116:119], v181 offset:512
    ds_read_b128 v[120:123], v182 offset:512
    ds_read_b128 v[124:127], v183 offset:512
    ds_read_b128 v[128:131], v180 offset:768
    ds_read_b128 v[132:135], v181 offset:768
    ds_read_b128 v[136:139], v182 offset:768
    ds_read_b128 v[140:143], v183 offset:768
L_ar_21:
    buffer_load_dwordx4 v[208:211], v4, s[44:47], s88 offen  nt
    buffer_load_dwordx4 v[212:215], v4, s[44:47], s89 offen  nt
    s_waitcnt vmcnt(4)
L_qk_22:
    s_barrier
    ds_read_b128 v[64:67], v184 offset:0
    ds_read_b128 v[68:71], v185 offset:0
    ds_read_b128 v[72:75], v186 offset:0
    ds_read_b128 v[76:79], v187 offset:0
    ds_read_b128 v[216:219], v184 offset:256
    s_waitcnt lgkmcnt(4)
    v_mfma_f32_16x16x32_bf16 v[144:147], v[80:83], v[64:67], 0
    buffer_store_dword v247, v252, s[36:39], s91 offen sc1
    ds_read_b128 v[220:223], v185 offset:256
    s_waitcnt lgkmcnt(4)
    v_mfma_f32_16x16x32_bf16 v[144:147], v[84:87], v[68:71], v[144:147]
    ds_read_b128 v[64:67], v186 offset:256
    s_waitcnt lgkmcnt(4)
    v_mfma_f32_16x16x32_bf16 v[144:147], v[88:91], v[72:75], v[144:147]
    ds_read_b128 v[68:71], v187 offset:256
    s_waitcnt lgkmcnt(4)
    v_mfma_f32_16x16x32_bf16 v[144:147], v[92:95], v[76:79], v[144:147]
    ds_read_b128 v[72:75], v184 offset:512
    s_waitcnt lgkmcnt(4)
    v_mfma_f32_16x16x32_bf16 v[144:147], v[96:99], v[216:219], v[144:147]
    ds_read_b128 v[76:79], v185 offset:512
    s_waitcnt lgkmcnt(4)
    v_mfma_f32_16x16x32_bf16 v[144:147], v[100:103], v[220:223], v[144:147]
    ds_read_b128 v[216:219], v186 offset:512
    s_waitcnt lgkmcnt(4)
    v_mfma_f32_16x16x32_bf16 v[144:147], v[104:107], v[64:67], v[144:147]
    ds_read_b128 v[220:223], v187 offset:512
    s_waitcnt lgkmcnt(4)
    v_mfma_f32_16x16x32_bf16 v[144:147], v[108:111], v[68:71], v[144:147]
    ds_read_b128 v[64:67], v184 offset:768
    s_waitcnt lgkmcnt(4)
    v_mfma_f32_16x16x32_bf16 v[144:147], v[112:115], v[72:75], v[144:147]
    ds_read_b128 v[68:71], v185 offset:768
    s_waitcnt lgkmcnt(4)
    v_mfma_f32_16x16x32_bf16 v[144:147], v[116:119], v[76:79], v[144:147]
    ds_read_b128 v[72:75], v186 offset:768
    s_waitcnt lgkmcnt(4)
    v_mfma_f32_16x16x32_bf16 v[144:147], v[120:123], v[216:219], v[144:147]
    ds_read_b128 v[76:79], v187 offset:768
    s_waitcnt lgkmcnt(4)
    v_mfma_f32_16x16x32_bf16 v[144:147], v[124:127], v[220:223], v[144:147]
    s_waitcnt lgkmcnt(3)
    v_mfma_f32_16x16x32_bf16 v[144:147], v[128:131], v[64:67], v[144:147]
    s_waitcnt lgkmcnt(2)
    v_mfma_f32_16x16x32_bf16 v[144:147], v[132:135], v[68:71], v[144:147]
    s_waitcnt lgkmcnt(1)
    v_mfma_f32_16x16x32_bf16 v[144:147], v[136:139], v[72:75], v[144:147]
    s_waitcnt lgkmcnt(0)
    v_mfma_f32_16x16x32_bf16 v[144:147], v[140:143], v[76:79], v[144:147]
    s_nop 7
    v_maximum3_f32 v12, v144, v145, v146
    v_maximum3_f32 v12, v12, v147, v147
    v_mov_b32 v13, v12
    s_nop 1
    v_permlane16_swap_b32 v12, v13
    v_maximum3_f32 v12, v12, v13, v13
    v_mov_b32 v13, v12
    s_nop 1
    v_permlane32_swap_b32 v12, v13
    v_maximum3_f32 v12, v12, v13, v13
    ds_write_b32 v248, v12
    s_waitcnt lgkmcnt(0)
    s_barrier
    ds_read_b128 v[148:151], v249
    ds_read_b128 v[152:155], v249 offset:16
    ds_read_b64_tr_b16 v[80:81], v189 offset:32768
    ds_read_b64_tr_b16 v[82:83], v189 offset:49152
    ds_read_b64_tr_b16 v[84:85], v189 offset:33024
    ds_read_b64_tr_b16 v[86:87], v189 offset:49408
    ds_read_b64_tr_b16 v[88:89], v189 offset:33280
    ds_read_b64_tr_b16 v[90:91], v189 offset:49664
    ds_read_b64_tr_b16 v[92:93], v189 offset:33536
    ds_read_b64_tr_b16 v[94:95], v189 offset:49920
    s_waitcnt lgkmcnt(9)
    v_maximum3_f32 v12, v148, v149, v150
    s_waitcnt lgkmcnt(8)
    v_maximum3_f32 v13, v151, v152, v153
    v_maximum3_f32 v12, v154, v155, v12
    v_maximum3_f32 v14, v12, v13, v13
    v_sub_f32 v144, v144, v14
    v_sub_f32 v145, v145, v14
    v_sub_f32 v146, v146, v14
    v_sub_f32 v147, v147, v14
    v_cmp_u_f32 vcc, v14, v14
    v_exp_f32 v144, v144
    v_exp_f32 v145, v145
    v_exp_f32 v146, v146
    v_exp_f32 v147, v147
    s_cbranch_vccnz L_slow_24
L_cont_23:
    v_cvt_pk_bf16_f32 v12, v144, v145
    v_cvt_pk_bf16_f32 v13, v146, v147
    ds_write_b64 v250, v[12:13]
    s_waitcnt lgkmcnt(0)
    s_barrier
    ds_read_b128 v[148:151], v253 offset:0
    ds_read_b128 v[152:155], v253 offset:1024
    ds_read_b128 v[156:159], v253 offset:2048
    ds_read_b128 v[160:163], v253 offset:3072
    s_waitcnt lgkmcnt(3)
    v_mfma_f32_16x16x32_bf16 v[164:167], v[148:151], v[16:19], 0
    v_mfma_f32_16x16x32_bf16 v[168:171], v[148:151], v[20:23], 0
    s_waitcnt lgkmcnt(2)
    v_mfma_f32_16x16x32_bf16 v[164:167], v[152:155], v[32:35], v[164:167]
    v_mfma_f32_16x16x32_bf16 v[168:171], v[152:155], v[36:39], v[168:171]
    s_waitcnt lgkmcnt(1)
    v_mfma_f32_16x16x32_bf16 v[164:167], v[156:159], v[48:51], v[164:167]
    v_mfma_f32_16x16x32_bf16 v[168:171], v[156:159], v[52:55], v[168:171]
    s_waitcnt lgkmcnt(0)
    v_mfma_f32_16x16x32_bf16 v[164:167], v[160:163], v[80:83], v[164:167]
    v_mfma_f32_16x16x32_bf16 v[168:171], v[160:163], v[84:87], v[168:171]
    v_mfma_f32_16x16x32_bf16 v[172:175], v[148:151], v[24:27], 0
    v_mfma_f32_16x16x32_bf16 v[176:179], v[148:151], v[28:31], 0
    v_mfma_f32_16x16x32_bf16 v[172:175], v[152:155], v[40:43], v[172:175]
    v_mfma_f32_16x16x32_bf16 v[176:179], v[152:155], v[44:47], v[176:179]
    v_mfma_f32_16x16x32_bf16 v[172:175], v[156:159], v[56:59], v[172:175]
    v_mfma_f32_16x16x32_bf16 v[176:179], v[156:159], v[60:63], v[176:179]
    v_mfma_f32_16x16x32_bf16 v[172:175], v[160:163], v[88:91], v[172:175]
    v_mfma_f32_16x16x32_bf16 v[176:179], v[160:163], v[92:95], v[176:179]
    v_cvt_pk_bf16_f32 v232, v164, v168
    v_cvt_pk_bf16_f32 v234, v165, v169
    v_cvt_pk_bf16_f32 v236, v166, v170
    v_cvt_pk_bf16_f32 v238, v167, v171
    s_nop 3
    v_cvt_pk_bf16_f32 v233, v172, v176
    buffer_store_dwordx2 v[232:233], v251, s[36:39], 0 offen sc1
    v_cvt_pk_bf16_f32 v235, v173, v177
    buffer_store_dwordx2 v[234:235], v251, s[36:39], s56 offen sc1
    v_cvt_pk_bf16_f32 v237, v174, v178
    buffer_store_dwordx2 v[236:237], v251, s[36:39], s57 offen sc1
    v_cvt_pk_bf16_f32 v239, v175, v179
    buffer_store_dwordx2 v[238:239], v251, s[36:39], s58 offen sc1
    s_cmp_lg_u32 s72, 0
    s_cbranch_scc1 L_nol_25
    v_mov_b32 v144, 0x3f803f80
    v_mov_b32 v145, 0x3f803f80
    v_mov_b32 v146, 0x3f803f80
    v_mov_b32 v147, 0x3f803f80
    s_nop 1
    v_mfma_f32_16x16x32_bf16 v[164:167], v[144:147], v[148:151], 0
    v_mfma_f32_16x16x32_bf16 v[164:167], v[144:147], v[152:155], v[164:167]
    v_mfma_f32_16x16x32_bf16 v[164:167], v[144:147], v[156:159], v[164:167]
    v_mfma_f32_16x16x32_bf16 v[164:167], v[144:147], v[160:163], v[164:167]
    v_lshlrev_b32 v145, 10, v1
    s_nop 6
    v_mov_b32 v15, v164

L_nol_25:
    s_barrier
    s_waitcnt vmcnt(5)
    s_add_u32 m0, s82, 0
    s_nop 0
    buffer_load_dwordx4 v242, s[40:43], 0 offen offset:0  lds
    ds_write_b128 v240, v[200:203] offset:0
    s_mov_b32 s85, 7168
    buffer_load_dwordx4 v242, s[40:43], s85 offen offset:1024  lds
    ds_write_b128 v241, v[204:207] offset:1024
    s_mov_b32 s85, 14336
    buffer_load_dwordx4 v242, s[40:43], s85 offen offset:2048  lds
    ds_write_b128 v240, v[208:211] offset:2048
    s_mov_b32 s85, 21504
    buffer_load_dwordx4 v242, s[40:43], s85 offen offset:3072  lds
    ds_write_b128 v241, v[212:215] offset:3072
    s_add_u32 m0, s82, 4096
    s_mov_b32 s85, 32768
    buffer_load_dwordx4 v242, s[40:43], s85 offen offset:0  lds
    v_xor_b32 v225, 32, v195
    v_xor_b32 v226, 64, v195
    v_xor_b32 v227, 0x60, v195
    s_waitcnt lgkmcnt(0)
    s_cmp_lg_u32 s72, 0
    s_waitcnt vmcnt(5)
    s_barrier
    s_cbranch_scc1 L_nost_26
    s_mov_b64 exec, 0xffff
    buffer_atomic_swap_x2 v[14:15], v145, s[36:39], s59 offen sc1
    s_mov_b64 exec, -1
L_nost_26:
    s_mov_b32 s85, 39936
    buffer_load_dwordx4 v242, s[40:43], s85 offen offset:1024  lds
    s_mov_b32 s85, 47104
    buffer_load_dwordx4 v242, s[40:43], s85 offen offset:2048  lds
    s_mov_b32 s85, 54272
    buffer_load_dwordx4 v242, s[40:43], s85 offen offset:3072  lds
    s_barrier
    v_mov_b32 v176, 0
    v_mov_b32 v177, 0
    s_mov_b64 exec, 0xffff
    buffer_atomic_or_x2 v[176:177], v243, s[36:39], 0 offen sc0 sc1
    s_mov_b64 exec, -1
    s_barrier
    s_waitcnt vmcnt(5)
    s_add_u32 m0, s82, 8192
    s_mov_b32 s85, 65536
    buffer_load_dwordx4 v242, s[40:43], s85 offen offset:0  lds
    ds_read_b64_tr_b16 v[144:145], v199 offset:0
    ds_read_b64_tr_b16 v[146:147], v199 offset:4096
    ds_read_b64_tr_b16 v[148:149], v199 offset:8192
    ds_read_b64_tr_b16 v[150:151], v199 offset:12288
    s_mov_b32 s85, 72704
    buffer_load_dwordx4 v242, s[40:43], s85 offen offset:1024  lds
    ds_read_b64_tr_b16 v[152:153], v199 offset:16384
    ds_read_b64_tr_b16 v[154:155], v199 offset:20480
    ds_read_b64_tr_b16 v[156:157], v199 offset:24576
    ds_read_b64_tr_b16 v[158:159], v199 offset:28672
    s_mov_b32 s85, 79872
    buffer_load_dwordx4 v242, s[40:43], s85 offen offset:2048  lds
    ds_read_b64_tr_b16 v[80:81], v195 offset:0
    ds_read_b64_tr_b16 v[82:83], v195 offset:2048
    ds_read_b64_tr_b16 v[88:89], v225 offset:0
    ds_read_b64_tr_b16 v[90:91], v225 offset:2048
    s_mov_b32 s85, 87040
    buffer_load_dwordx4 v242, s[40:43], s85 offen offset:3072  lds
    ds_read_b64_tr_b16 v[96:97], v226 offset:0
    ds_read_b64_tr_b16 v[98:99], v226 offset:2048
    ds_read_b64_tr_b16 v[104:105], v227 offset:0
    ds_read_b64_tr_b16 v[106:107], v227 offset:2048
    s_mov_b32 s87, 0
    s_waitcnt vmcnt(4)
    v_max_u32 v12, v176, v177
    v_cmp_eq_u32 vcc, -1, v12
    s_nop 0
    s_cbranch_vccz L_first
    s_waitcnt vmcnt(0)
    s_add_u32 m0, s82, 12288
    s_mov_b32 s85, 98304
    buffer_load_dwordx4 v242, s[40:43], s85 offen offset:0  lds
    ds_read_b64_tr_b16 v[84:85], v195 offset:4096
    ds_read_b64_tr_b16 v[86:87], v195 offset:6144
    ds_read_b64_tr_b16 v[92:93], v225 offset:4096
    ds_read_b64_tr_b16 v[94:95], v225 offset:6144
    s_mov_b32 s85, 105472
    buffer_load_dwordx4 v242, s[40:43], s85 offen offset:1024  lds
    ds_read_b64_tr_b16 v[100:101], v226 offset:4096
    ds_read_b64_tr_b16 v[102:103], v226 offset:6144
    ds_read_b64_tr_b16 v[108:109], v227 offset:4096
    ds_read_b64_tr_b16 v[110:111], v227 offset:6144
    s_mov_b32 s85, 112640
    buffer_load_dwordx4 v242, s[40:43], s85 offen offset:2048  lds
    ds_read_b64_tr_b16 v[112:113], v195 offset:8192
    ds_read_b64_tr_b16 v[114:115], v195 offset:10240
    ds_read_b64_tr_b16 v[120:121], v225 offset:8192
    ds_read_b64_tr_b16 v[122:123], v225 offset:10240
    s_mov_b32 s85, 119808
    buffer_load_dwordx4 v242, s[40:43], s85 offen offset:3072  lds
    ds_read_b64_tr_b16 v[128:129], v226 offset:8192
    ds_read_b64_tr_b16 v[130:131], v226 offset:10240
    ds_read_b64_tr_b16 v[136:137], v227 offset:8192
    ds_read_b64_tr_b16 v[138:139], v227 offset:10240
    v_mov_b32 v182, 0
    v_mov_b32 v183, 0
    s_mov_b64 exec, 0xffff
    buffer_atomic_or_x2 v[182:183], v243, s[36:39], 0 offen sc0 sc1
    s_mov_b64 exec, -1
    s_waitcnt vmcnt(1)
    ds_read_b64_tr_b16 v[116:117], v195 offset:12288
    ds_read_b64_tr_b16 v[118:119], v195 offset:14336
    ds_read_b64_tr_b16 v[124:125], v225 offset:12288
    ds_read_b64_tr_b16 v[126:127], v225 offset:14336
    ds_read_b64_tr_b16 v[132:133], v226 offset:12288
    ds_read_b64_tr_b16 v[134:135], v226 offset:14336
    ds_read_b64_tr_b16 v[140:141], v227 offset:12288
    ds_read_b64_tr_b16 v[142:143], v227 offset:14336
L_sp:
    v_mov_b32 v184, 0
    v_mov_b32 v185, 0
    s_mov_b64 exec, 0xffff
    buffer_atomic_or_x2 v[184:185], v243, s[36:39], 0 offen sc0 sc1
    s_mov_b64 exec, -1
    s_waitcnt vmcnt(1)
    v_mov_b32 v176, v182
    v_mov_b32 v177, v183
    v_max_u32 v12, v182, v183
    v_cmp_eq_u32 vcc, -1, v12
    s_nop 0
    s_cbranch_vccz L_spok

    v_mov_b32 v182, 0
    v_mov_b32 v183, 0
    s_mov_b64 exec, 0xffff
    buffer_atomic_or_x2 v[182:183], v243, s[36:39], 0 offen sc0 sc1
    s_mov_b64 exec, -1
    s_waitcnt vmcnt(1)
    v_mov_b32 v176, v184
    v_mov_b32 v177, v185
    v_max_u32 v12, v184, v185
    v_cmp_eq_u32 vcc, -1, v12
    s_nop 0
    s_cbranch_vccz L_spok

    s_add_u32 s87, s87, 1
    s_cmp_lt_u32 s87, 32768
    s_cbranch_scc1 L_sp
L_spok:
    buffer_load_dwordx4 v[160:163], v5, s[36:39], s61 offen offset:0 sc1
    buffer_load_dwordx4 v[164:167], v5, s[36:39], s61 offen offset:1024 sc1
    buffer_load_dwordx4 v[168:171], v5, s[36:39], s61 offen offset:2048 sc1
    buffer_load_dwordx4 v[172:175], v5, s[36:39], s61 offen offset:3072 sc1
    v_max_f32_dpp v14, v176, v176 row_ror:8 row_mask:0xf bank_mask:0xf
    s_nop 1
    v_max_f32_dpp v14, v14, v14 row_ror:4 row_mask:0xf bank_mask:0xf
    s_nop 1
    v_max_f32_dpp v14, v14, v14 row_ror:2 row_mask:0xf bank_mask:0xf
    s_nop 1
    v_max_f32_dpp v14, v14, v14 row_ror:1 row_mask:0xf bank_mask:0xf
    v_sub_f32 v176, v176, v14
    v_exp_f32 v176, v176
    s_nop 0
    v_cvt_pk_bf16_f32 v176, v176, v176
    ds_write_b32 v198, v176
    ds_read_b128 v[32:35], v7
    v_and_b32 v13, 0xffff0000, v176
    v_mul_f32 v15, v13, v177
    s_nop 1
    v_add_f32_dpp v15, v15, v15 row_ror:8 row_mask:0xf bank_mask:0xf
    s_nop 1
    v_add_f32_dpp v15, v15, v15 row_ror:4 row_mask:0xf bank_mask:0xf
    s_nop 1
    v_add_f32_dpp v15, v15, v15 row_ror:2 row_mask:0xf bank_mask:0xf
    s_nop 1
    v_add_f32_dpp v15, v15, v15 row_ror:1 row_mask:0xf bank_mask:0xf
    v_mov_b32 v36, 0
    v_mov_b32 v37, 0
    v_mov_b32 v38, 0
    v_mov_b32 v39, 0
    v_mov_b32 v48, 0
    v_mov_b32 v49, 0
    v_mov_b32 v52, 0
    v_mov_b32 v53, 0
    v_mov_b32 v56, 0
    v_mov_b32 v57, 0
    v_mov_b32 v60, 0
    v_mov_b32 v61, 0
    s_bfe_u32 s84, s90, 0x30003
    s_lshl_b32 s84, s84, 11
    s_add_u32 s84, s84, 851968
    s_cmp_eq_u32 s72, 0
    s_cselect_b32 s84, s84, 0x7f000000
    v_lshl_add_u32 v40, v1, 7, s84
    v_mov_b32 v41, 1
    s_waitcnt lgkmcnt(0)
    ds_write_b64 v245, v[14:15]
    v_and_b32 v16, v32, v228
    v_and_b32 v17, v32, v229
    v_and_b32 v18, v32, v230
    v_and_b32 v19, v32, v231
    v_and_b32 v20, v33, v228
    v_and_b32 v21, v33, v229
    v_and_b32 v22, v33, v230
    v_and_b32 v23, v33, v231
    v_and_b32 v24, v34, v228
    v_and_b32 v25, v34, v229
    v_and_b32 v26, v34, v230
    v_and_b32 v27, v34, v231
    v_and_b32 v28, v35, v228
    v_and_b32 v29, v35, v229
    v_and_b32 v30, v35, v230
    v_and_b32 v31, v35, v231
    s_waitcnt vmcnt(3)
    v_mfma_f32_16x16x32_bf16 v[8:11], v[16:19], v[160:163], 0
    s_waitcnt vmcnt(2)
    v_mfma_f32_16x16x32_bf16 v[8:11], v[20:23], v[164:167], v[8:11]
    s_waitcnt vmcnt(1)
    v_mfma_f32_16x16x32_bf16 v[8:11], v[24:27], v[168:171], v[8:11]
    s_waitcnt vmcnt(0)
    v_mfma_f32_16x16x32_bf16 v[8:11], v[28:31], v[172:175], v[8:11]
    s_nop 7
    v_cvt_pk_bf16_f32 v8, v8, v9
    v_cvt_pk_bf16_f32 v9, v10, v11
    ds_write2_b32 v191, v8, v9 offset0:0 offset1:32
    s_waitcnt lgkmcnt(0)
    s_barrier
    ds_read_b64 v[12:13], v246 offset:1024
    ds_read_b128 v[176:179], v192
    ds_read_b128 v[180:183], v192 offset:64
    s_waitcnt lgkmcnt(2)
    v_max_f32_dpp v14, v12, v12 row_ror:4 row_mask:0xf bank_mask:0xf
    s_waitcnt lgkmcnt(1)
    v_smfmac_f32_16x16x64_bf16 v[36:39], v[176:179], v[144:151], v190
    v_max_f32_dpp v14, v14, v14 row_ror:2 row_mask:0xf bank_mask:0xf
    s_waitcnt lgkmcnt(0)
    v_smfmac_f32_16x16x64_bf16 v[36:39], v[180:183], v[152:159], v190
    v_max_f32_dpp v14, v14, v14 row_ror:1 row_mask:0xf bank_mask:0xf
    v_sub_f32 v12, v12, v14
    v_exp_f32 v12, v12
    s_nop 0
    v_mul_f32 v13, v12, v13
    v_mov_b32_dpp v14, v12 row_newbcast:0 row_mask:0xf bank_mask:0xf
    v_mov_b32_dpp v15, v12 row_newbcast:1 row_mask:0xf bank_mask:0xf
    s_nop 0
    v_add_f32 v36, v36, v37
    v_add_f32 v38, v38, v39
    v_mul_f32 v8, v14, v36
    v_fmac_f32 v8, v15, v38
    v_cvt_pk_bf16_f32 v8, v8, v8
    ds_write_b16 v193, v8
    v_add_f32_dpp v13, v13, v13 row_ror:4 row_mask:0xf bank_mask:0xf
    s_nop 1
    v_add_f32_dpp v13, v13, v13 row_ror:2 row_mask:0xf bank_mask:0xf
    s_cmp_lg_u32 s72, 0
    s_cbranch_scc1 L_hs_27
    s_mov_b64 exec, 0xffff
    buffer_atomic_add v41, v40, s[36:39], 0 offen sc1
    s_mov_b64 exec, -1
L_hs_27:
    s_waitcnt lgkmcnt(0)
    s_barrier
    ds_read_b128 v[176:179], v194
    ds_read_b128 v[180:183], v194 offset:64
    v_add_f32_dpp v13, v13, v13 row_ror:1 row_mask:0xf bank_mask:0xf
    v_rcp_f32 v13, v13
    s_waitcnt lgkmcnt(1)
    v_smfmac_f32_16x16x64_bf16 v[48:51], v[176:179], v[80:87], v190
    v_smfmac_f32_16x16x64_bf16 v[56:59], v[176:179], v[96:103], v190
    v_smfmac_f32_16x16x64_bf16 v[52:55], v[176:179], v[88:95], v190
    v_smfmac_f32_16x16x64_bf16 v[60:63], v[176:179], v[104:111], v190
    s_waitcnt lgkmcnt(0)
    v_smfmac_f32_16x16x64_bf16 v[48:51], v[180:183], v[112:119], v190
    v_smfmac_f32_16x16x64_bf16 v[56:59], v[180:183], v[128:135], v190
    v_smfmac_f32_16x16x64_bf16 v[52:55], v[180:183], v[120:127], v190
    v_smfmac_f32_16x16x64_bf16 v[60:63], v[180:183], v[136:143], v190
    s_nop 4
    v_add_f32 v48, v48, v49
    v_add_f32 v56, v56, v57
    v_add_f32 v52, v52, v53
    v_add_f32 v60, v60, v61
    v_permlane32_swap_b32 v48, v56
    s_nop 0
    v_permlane32_swap_b32 v52, v60
    v_add_f32 v48, v48, v56
    v_add_f32 v52, v52, v60
    s_nop 1
    v_permlane16_swap_b32 v48, v52
    v_mul_f32 v160, v48, v13
    v_fmac_f32 v160, v52, v13
    buffer_store_dword v160, v252, s[36:39], s91 offen sc1
    s_endpgm
L_first:
    buffer_load_dwordx4 v[160:163], v5, s[36:39], s61 offen offset:0 sc1
    buffer_load_dwordx4 v[164:167], v5, s[36:39], s61 offen offset:1024 sc1
    buffer_load_dwordx4 v[168:171], v5, s[36:39], s61 offen offset:2048 sc1
    buffer_load_dwordx4 v[172:175], v5, s[36:39], s61 offen offset:3072 sc1
    v_max_f32_dpp v14, v176, v176 row_ror:8 row_mask:0xf bank_mask:0xf
    s_nop 1
    v_max_f32_dpp v14, v14, v14 row_ror:4 row_mask:0xf bank_mask:0xf
    s_nop 1
    v_max_f32_dpp v14, v14, v14 row_ror:2 row_mask:0xf bank_mask:0xf
    s_nop 1
    v_max_f32_dpp v14, v14, v14 row_ror:1 row_mask:0xf bank_mask:0xf
    v_sub_f32 v176, v176, v14
    v_exp_f32 v176, v176
    s_nop 0
    v_cvt_pk_bf16_f32 v176, v176, v176
    ds_write_b32 v198, v176
    ds_read_b128 v[32:35], v7
    v_and_b32 v13, 0xffff0000, v176
    v_mul_f32 v15, v13, v177
    s_nop 1
    v_add_f32_dpp v15, v15, v15 row_ror:8 row_mask:0xf bank_mask:0xf
    s_nop 1
    v_add_f32_dpp v15, v15, v15 row_ror:4 row_mask:0xf bank_mask:0xf
    s_nop 1
    v_add_f32_dpp v15, v15, v15 row_ror:2 row_mask:0xf bank_mask:0xf
    s_nop 1
    v_add_f32_dpp v15, v15, v15 row_ror:1 row_mask:0xf bank_mask:0xf
    v_mov_b32 v36, 0
    v_mov_b32 v37, 0
    v_mov_b32 v38, 0
    v_mov_b32 v39, 0
    v_mov_b32 v48, 0
    v_mov_b32 v49, 0
    v_mov_b32 v52, 0
    v_mov_b32 v53, 0
    v_mov_b32 v56, 0
    v_mov_b32 v57, 0
    v_mov_b32 v60, 0
    v_mov_b32 v61, 0
    s_bfe_u32 s84, s90, 0x30003
    s_lshl_b32 s84, s84, 11
    s_add_u32 s84, s84, 851968
    s_cmp_eq_u32 s72, 0
    s_cselect_b32 s84, s84, 0x7f000000
    v_lshl_add_u32 v40, v1, 7, s84
    v_mov_b32 v41, 1
    s_waitcnt lgkmcnt(0)
    ds_write_b64 v245, v[14:15]
    v_and_b32 v16, v32, v228
    v_and_b32 v17, v32, v229
    v_and_b32 v18, v32, v230
    v_and_b32 v19, v32, v231
    v_and_b32 v20, v33, v228
    v_and_b32 v21, v33, v229
    v_and_b32 v22, v33, v230
    v_and_b32 v23, v33, v231
    v_and_b32 v24, v34, v228
    v_and_b32 v25, v34, v229
    v_and_b32 v26, v34, v230
    v_and_b32 v27, v34, v231
    v_and_b32 v28, v35, v228
    v_and_b32 v29, v35, v229
    v_and_b32 v30, v35, v230
    v_and_b32 v31, v35, v231
    s_waitcnt vmcnt(4)
    s_add_u32 m0, s82, 12288
    s_mov_b32 s85, 98304
    buffer_load_dwordx4 v242, s[40:43], s85 offen offset:0  lds
    ds_read_b64_tr_b16 v[84:85], v195 offset:4096
    ds_read_b64_tr_b16 v[86:87], v195 offset:6144
    ds_read_b64_tr_b16 v[92:93], v225 offset:4096
    ds_read_b64_tr_b16 v[94:95], v225 offset:6144
    s_mov_b32 s85, 105472
    buffer_load_dwordx4 v242, s[40:43], s85 offen offset:1024  lds
    ds_read_b64_tr_b16 v[100:101], v226 offset:4096
    ds_read_b64_tr_b16 v[102:103], v226 offset:6144
    ds_read_b64_tr_b16 v[108:109], v227 offset:4096
    ds_read_b64_tr_b16 v[110:111], v227 offset:6144
    s_mov_b32 s85, 112640
    buffer_load_dwordx4 v242, s[40:43], s85 offen offset:2048  lds
    ds_read_b64_tr_b16 v[112:113], v195 offset:8192
    ds_read_b64_tr_b16 v[114:115], v195 offset:10240
    ds_read_b64_tr_b16 v[120:121], v225 offset:8192
    ds_read_b64_tr_b16 v[122:123], v225 offset:10240
    s_mov_b32 s85, 119808
    buffer_load_dwordx4 v242, s[40:43], s85 offen offset:3072  lds
    ds_read_b64_tr_b16 v[128:129], v226 offset:8192
    ds_read_b64_tr_b16 v[130:131], v226 offset:10240
    ds_read_b64_tr_b16 v[136:137], v227 offset:8192
    ds_read_b64_tr_b16 v[138:139], v227 offset:10240
    s_waitcnt vmcnt(7)
    v_mfma_f32_16x16x32_bf16 v[8:11], v[16:19], v[160:163], 0
    s_waitcnt vmcnt(6)
    v_mfma_f32_16x16x32_bf16 v[8:11], v[20:23], v[164:167], v[8:11]
    s_waitcnt vmcnt(5)
    v_mfma_f32_16x16x32_bf16 v[8:11], v[24:27], v[168:171], v[8:11]
    s_waitcnt vmcnt(4)
    v_mfma_f32_16x16x32_bf16 v[8:11], v[28:31], v[172:175], v[8:11]
    s_nop 7
    v_cvt_pk_bf16_f32 v8, v8, v9
    v_cvt_pk_bf16_f32 v9, v10, v11
    ds_write2_b32 v191, v8, v9 offset0:0 offset1:32
    s_waitcnt lgkmcnt(0)
    s_barrier
    ds_read_b64 v[12:13], v246 offset:1024
    ds_read_b128 v[176:179], v192
    ds_read_b128 v[180:183], v192 offset:64
    s_waitcnt lgkmcnt(2)
    v_max_f32_dpp v14, v12, v12 row_ror:4 row_mask:0xf bank_mask:0xf
    s_waitcnt lgkmcnt(1)
    v_smfmac_f32_16x16x64_bf16 v[36:39], v[176:179], v[144:151], v190
    v_max_f32_dpp v14, v14, v14 row_ror:2 row_mask:0xf bank_mask:0xf
    s_waitcnt lgkmcnt(0)
    v_smfmac_f32_16x16x64_bf16 v[36:39], v[180:183], v[152:159], v190
    v_max_f32_dpp v14, v14, v14 row_ror:1 row_mask:0xf bank_mask:0xf
    v_sub_f32 v12, v12, v14
    v_exp_f32 v12, v12
    s_nop 0
    v_mul_f32 v13, v12, v13
    v_mov_b32_dpp v14, v12 row_newbcast:0 row_mask:0xf bank_mask:0xf
    v_mov_b32_dpp v15, v12 row_newbcast:1 row_mask:0xf bank_mask:0xf
    s_nop 0
    v_add_f32 v36, v36, v37
    v_add_f32 v38, v38, v39
    v_mul_f32 v8, v14, v36
    v_fmac_f32 v8, v15, v38
    v_cvt_pk_bf16_f32 v8, v8, v8
    ds_write_b16 v193, v8
    v_add_f32_dpp v13, v13, v13 row_ror:4 row_mask:0xf bank_mask:0xf
    s_nop 1
    v_add_f32_dpp v13, v13, v13 row_ror:2 row_mask:0xf bank_mask:0xf
    s_mov_b64 exec, 0xffff
    buffer_atomic_add v41, v40, s[36:39], 0 offen sc1
    s_mov_b64 exec, -1
    s_waitcnt vmcnt(1)
    ds_read_b64_tr_b16 v[116:117], v195 offset:12288
    ds_read_b64_tr_b16 v[118:119], v195 offset:14336
    ds_read_b64_tr_b16 v[124:125], v225 offset:12288
    ds_read_b64_tr_b16 v[126:127], v225 offset:14336
    ds_read_b64_tr_b16 v[132:133], v226 offset:12288
    ds_read_b64_tr_b16 v[134:135], v226 offset:14336
    ds_read_b64_tr_b16 v[140:141], v227 offset:12288
    ds_read_b64_tr_b16 v[142:143], v227 offset:14336
    s_waitcnt lgkmcnt(8)
    s_barrier
    ds_read_b128 v[176:179], v194
    ds_read_b128 v[180:183], v194 offset:64
    v_add_f32_dpp v13, v13, v13 row_ror:1 row_mask:0xf bank_mask:0xf
    v_rcp_f32 v13, v13
    s_waitcnt lgkmcnt(1)
    v_smfmac_f32_16x16x64_bf16 v[48:51], v[176:179], v[80:87], v190
    v_smfmac_f32_16x16x64_bf16 v[56:59], v[176:179], v[96:103], v190
    v_smfmac_f32_16x16x64_bf16 v[52:55], v[176:179], v[88:95], v190
    v_smfmac_f32_16x16x64_bf16 v[60:63], v[176:179], v[104:111], v190
    s_waitcnt lgkmcnt(0)
    v_smfmac_f32_16x16x64_bf16 v[48:51], v[180:183], v[112:119], v190
    v_smfmac_f32_16x16x64_bf16 v[56:59], v[180:183], v[128:135], v190
    v_smfmac_f32_16x16x64_bf16 v[52:55], v[180:183], v[120:127], v190
    v_smfmac_f32_16x16x64_bf16 v[60:63], v[180:183], v[136:143], v190
    s_nop 4
    v_add_f32 v48, v48, v49
    v_add_f32 v56, v56, v57
    v_add_f32 v52, v52, v53
    v_add_f32 v60, v60, v61
    v_permlane32_swap_b32 v48, v56
    s_nop 0
    v_permlane32_swap_b32 v52, v60
    v_add_f32 v48, v48, v56
    v_add_f32 v52, v52, v60
    s_nop 1
    v_permlane16_swap_b32 v48, v52
    v_mul_f32 v160, v48, v13
    v_fmac_f32 v160, v52, v13
    buffer_store_dword v160, v252, s[36:39], s91 offen sc1
    s_endpgm
L_slow_9:
    s_cmp_lg_u32 s31, 0
    s_cbranch_scc1 L_cont_8
    s_mov_b32 s31, 1
    s_mov_b32 s87, 0
L_gat_28:
    buffer_load_dwordx4 v[216:219], v196, s[36:39], 0 offen sc1
    buffer_load_dwordx4 v[220:223], v197, s[36:39], 0 offen offset:1024 sc1
    s_add_u32 s87, s87, 1
    s_cmp_lt_u32 s87, 32768
    s_waitcnt vmcnt(0)
    v_max3_u32 v12, v216, v217, v218
    v_max3_u32 v13, v219, v220, v221
    v_max3_u32 v12, v222, v223, v12
    v_max_u32 v12, v12, v13
    v_cmp_eq_u32 vcc, -1, v12
    s_nop 0
    s_cbranch_vccz L_gatok_29
    s_cbranch_scc1 L_gat_28
L_gatok_29:
    v_add_u32 v12, s30, v5
    s_waitcnt lgkmcnt(0)
    ds_write_b128 v12, v[216:219]
    ds_write_b128 v12, v[220:223] offset:1024
    ds_read_b128 v[80:83], v180
    ds_read_b128 v[84:87], v181
    ds_read_b128 v[88:91], v182
    ds_read_b128 v[92:95], v183
    s_waitcnt lgkmcnt(0)
    s_branch L_qk_7
L_slow_24:
    s_cmp_lg_u32 s31, 0
    s_cbranch_scc1 L_cont_23
    s_mov_b32 s31, 1
    s_mov_b32 s87, 0
L_gat_30:
    buffer_load_dwordx4 v[216:219], v196, s[36:39], 0 offen sc1
    buffer_load_dwordx4 v[220:223], v197, s[36:39], 0 offen offset:1024 sc1
    s_add_u32 s87, s87, 1
    s_cmp_lt_u32 s87, 32768
    s_waitcnt vmcnt(0)
    v_max3_u32 v12, v216, v217, v218
    v_max3_u32 v13, v219, v220, v221
    v_max3_u32 v12, v222, v223, v12
    v_max_u32 v12, v12, v13
    v_cmp_eq_u32 vcc, -1, v12
    s_nop 0
    s_cbranch_vccz L_gatok_31
    s_cbranch_scc1 L_gat_30
L_gatok_31:
    v_add_u32 v12, s30, v5
    s_waitcnt lgkmcnt(0)
    ds_write_b128 v12, v[216:219]
    ds_write_b128 v12, v[220:223] offset:1024
    ds_read_b128 v[80:83], v180
    ds_read_b128 v[84:87], v181
    ds_read_b128 v[88:91], v182
    ds_read_b128 v[92:95], v183
    s_waitcnt lgkmcnt(0)
    s_branch L_qk_22
L_end:
    s_endpgm

.fill 64, 4, 0xbf800000
.section .rodata,"a"
.p2align 6
.amdhsa_kernel parallel_sum__compressed_kv_cla__glu_gated_bilinear__decode_kernel
  .amdhsa_next_free_vgpr 256
  .amdhsa_next_free_sgpr 102
  .amdhsa_accum_offset 256
  .amdhsa_group_segment_fixed_size 0
  .amdhsa_kernarg_size 104
  .amdhsa_user_sgpr_count 2
  .amdhsa_user_sgpr_kernarg_segment_ptr 1
  .amdhsa_system_sgpr_workgroup_id_x 1
.end_amdhsa_kernel
```
